```python
import torch

def _softmax(x, axis=-1):
    return torch.softmax(x, dim=axis)
def _gelu(x):
    return torch.nn.functional.gelu(x, approximate="tanh")
def _silu(x):
    return torch.nn.functional.silu(x)
def _sigmoid(x):
    return torch.sigmoid(x)
def _layernorm(x, axis=-1, eps=1e-5):
    m = x.mean(dim=axis, keepdim=True)
    v = x.var(dim=axis, keepdim=True, unbiased=False)
    return (x - m) / torch.sqrt(v + eps)
def _scatter_add(tgt, idx, src, axis=0):
    return tgt.clone().index_add_(axis, idx, src)
def _segment_sum(src, seg, n):
    out = torch.zeros((n,) + src.shape[1:], dtype=src.dtype)
    return out.index_add_(0, seg, src)
def _pad(x, pw):
    flat = tuple(v for pair in reversed(pw) for v in pair)
    return torch.nn.functional.pad(x, flat)

kernel_name = 'concat_heads__mha_block_cached__mha_block_cached__near_ridge'

def setup_inputs():

    _w = (lambda a: (lambda t: t.to(torch.bfloat16) if t.is_floating_point() else t)(torch.as_tensor(a)))
    def _A_setup():
        B, Sq, D = 8, 240, 640
        H, Sk, Dh = 32, 1024, 128
        return {
            "x": _w((lambda *s: torch.randn(*s, dtype=torch.bfloat16) * 0.8)(B, Sq, D)),
            "k_cache": _w((lambda *s: torch.randn(*s, dtype=torch.bfloat16) * 0.8)(B, H, Sk, Dh)),
            "v_cache": _w((lambda *s: torch.randn(*s, dtype=torch.bfloat16) * 0.05)(B, H, Sk, Dh)),
            "wq": _w((lambda *s: torch.randn(*s, dtype=torch.bfloat16) * 0.8)(D, H * Dh) * (D ** -0.5)),
            "wo": _w((lambda *s: torch.randn(*s, dtype=torch.bfloat16) * 0.05)(H * Dh, D) * ((H * Dh) ** -0.5)),
        }
    _A_in = _A_setup()

    def _B_setup():
        B, Sq, D = 8, 240, 640
        H, Sk, Dh = 32, 1024, 128
        return {
            "x": _w((lambda *s: torch.randn(*s, dtype=torch.bfloat16) * 0.8)(B, Sq, D)),
            "k_cache": _w((lambda *s: torch.randn(*s, dtype=torch.bfloat16) * 0.8)(B, H, Sk, Dh)),
            "v_cache": _w((lambda *s: torch.randn(*s, dtype=torch.bfloat16) * 0.05)(B, H, Sk, Dh)),
            "wq": _w((lambda *s: torch.randn(*s, dtype=torch.bfloat16) * 0.8)(D, H * Dh) * (D ** -0.5)),
            "wo": _w((lambda *s: torch.randn(*s, dtype=torch.bfloat16) * 0.05)(H * Dh, D) * ((H * Dh) ** -0.5)),
        }
    _B_in = _B_setup()

    return {
        "A_x": _A_in["x"],
        "A_k_cache": _A_in["k_cache"],
        "A_v_cache": _A_in["v_cache"],
        "A_wq": _A_in["wq"],
        "A_wo": _A_in["wo"],
        "B_x": _B_in["x"],
        "B_k_cache": _B_in["k_cache"],
        "B_v_cache": _B_in["v_cache"],
        "B_wq": _B_in["wq"],
        "B_wo": _B_in["wo"],
    }

def reference(A_x, A_k_cache, A_v_cache, A_wq, A_wo, B_x, B_k_cache, B_v_cache, B_wq, B_wo):
    def _A_ref(x, k_cache, v_cache, wq, wo):
        B, Sq, D = x.shape
        H, Dh = 32, 128
        q = (lambda x, *d: x.permute(*d))((x @ wq).reshape(B, Sq, H, Dh), 0, 2, 1, 3)
        scores = torch.einsum("bhqd,bhkd->bhqk", q, k_cache) * (Dh ** -0.5)
        p = _softmax(scores, axis=-1)
        o = torch.einsum("bhqk,bhkd->bhqd", p, v_cache)
        return (lambda x, *d: x.permute(*d))(o, 0, 2, 1, 3).reshape(B, Sq, H * Dh) @ wo

    def _B_ref(x, k_cache, v_cache, wq, wo):
        B, Sq, D = x.shape
        H, Dh = 32, 128
        q = (lambda x, *d: x.permute(*d))((x @ wq).reshape(B, Sq, H, Dh), 0, 2, 1, 3)
        scores = torch.einsum("bhqd,bhkd->bhqk", q, k_cache) * (Dh ** -0.5)
        p = _softmax(scores, axis=-1)
        o = torch.einsum("bhqk,bhkd->bhqd", p, v_cache)
        return (lambda x, *d: x.permute(*d))(o, 0, 2, 1, 3).reshape(B, Sq, H * Dh) @ wo

    a = _A_ref(A_x, A_k_cache, A_v_cache, A_wq, A_wo)
    b = _B_ref(B_x, B_k_cache, B_v_cache, B_wq, B_wo)
    return torch.concatenate([a, b], axis=-1)
```

```asm
; @launch kernel=gemm1_kernel grid=(256,1,1) block=(512,1,1) lds=131072
; @launch kernel=attn_kernel grid=(256,1,1) block=(512,1,1) lds=131072
; @launch kernel=gemm3_kernel grid=(256,1,1) block=(512,1,1) lds=114688
; @launch kernel=reduce_kernel grid=(1280,1,1) block=(256,1,1) lds=0
.amdgcn_target "amdgcn-amd-amdhsa--gfx950"
.text
.globl gemm1_kernel
.p2align 8
.type gemm1_kernel,@function
gemm1_kernel:
    s_cmp_ge_u32 s2, 256
    s_cbranch_scc1 gemm1_kernel_exit
    s_lshr_b32 s33, s2, 7
    s_lshr_b32 s34, s2, 4
    s_and_b32 s34, s34, 7
    s_and_b32 s35, s2, 15
    s_load_dwordx2 s[4:5], s[0:1], 0
    s_load_dwordx2 s[40:41], s[0:1], 40
    s_waitcnt lgkmcnt(0)
    s_cmp_lg_u32 s33, 0
    s_cselect_b32 s4, s40, s4
    s_cselect_b32 s5, s41, s5
    s_load_dwordx2 s[6:7], s[0:1], 24
    s_load_dwordx2 s[40:41], s[0:1], 64
    s_waitcnt lgkmcnt(0)
    s_cmp_lg_u32 s33, 0
    s_cselect_b32 s6, s40, s6
    s_cselect_b32 s7, s41, s7
    s_load_dwordx2 s[8:9], s[0:1], 96
    s_waitcnt lgkmcnt(0)
    s_mul_i32 s36, s34, 307200
    s_add_u32 s12, s4, s36
    s_addc_u32 s13, s5, 0
    s_mov_b32 s14, 307200
    s_mov_b32 s15, 0x00020000
    s_lshl_b32 s36, s35, 9
    s_add_u32 s16, s6, s36
    s_addc_u32 s17, s7, 0
    s_mov_b32 s18, 5235200
    s_mov_b32 s19, 0x00020000
    s_lshl_b32 s36, s33, 3
    s_add_u32 s36, s36, s34
    s_lshl_b32 s36, s36, 21
    s_lshl_b32 s37, s35, 17
    s_add_u32 s36, s36, s37
    s_add_u32 s20, s8, s36
    s_addc_u32 s21, s9, 0
    s_mov_b32 s22, 131072
    s_mov_b32 s23, 0x00020000
    v_and_b32 v1, 63, v0
    v_lshrrev_b32 v2, 6, v0
    s_nop 0
    v_readfirstlane_b32 s24, v2
    s_lshr_b32 s25, s24, 2
    s_and_b32 s26, s24, 3
    s_mul_i32 s27, s24, 32
    v_lshrrev_b32 v216, 3, v1
    v_add_u32 v216, s27, v216
    v_add_u32 v216, 0, v216
    v_lshrrev_b32 v217, 1, v216
    v_xor_b32 v217, v217, v1
    v_and_b32 v217, 7, v217
    v_min_u32 v216, 239, v216
    s_movk_i32 s27, 1280
    v_mul_lo_u32 v216, v216, s27
    v_lshlrev_b32 v217, 4, v217
    v_add_u32 v204, v216, v217
    s_mul_i32 s27, s24, 32
    v_lshrrev_b32 v216, 3, v1
    v_add_u32 v216, s27, v216
    v_add_u32 v216, 8, v216
    v_lshrrev_b32 v217, 1, v216
    v_xor_b32 v217, v217, v1
    v_and_b32 v217, 7, v217
    v_min_u32 v216, 239, v216
    s_movk_i32 s27, 1280
    v_mul_lo_u32 v216, v216, s27
    v_lshlrev_b32 v217, 4, v217
    v_add_u32 v205, v216, v217
    s_mul_i32 s27, s24, 32
    v_lshrrev_b32 v216, 3, v1
    v_add_u32 v216, s27, v216
    v_add_u32 v216, 16, v216
    v_lshrrev_b32 v217, 1, v216
    v_xor_b32 v217, v217, v1
    v_and_b32 v217, 7, v217
    v_min_u32 v216, 239, v216
    s_movk_i32 s27, 1280
    v_mul_lo_u32 v216, v216, s27
    v_lshlrev_b32 v217, 4, v217
    v_add_u32 v206, v216, v217
    s_mul_i32 s27, s24, 32
    v_lshrrev_b32 v216, 3, v1
    v_add_u32 v216, s27, v216
    v_add_u32 v216, 24, v216
    v_lshrrev_b32 v217, 1, v216
    v_xor_b32 v217, v217, v1
    v_and_b32 v217, 7, v217
    v_min_u32 v216, 239, v216
    s_movk_i32 s27, 1280
    v_mul_lo_u32 v216, v216, s27
    v_lshlrev_b32 v217, 4, v217
    v_add_u32 v207, v216, v217
    s_mul_i32 s27, s24, 4096
    v_lshlrev_b32 v216, 4, v1
    v_add_u32 v216, s27, v216
    v_add_u32 v216, 0, v216
    v_lshrrev_b32 v217, 9, v216
    v_and_b32 v218, 511, v216
    v_and_b32 v216, 3, v217
    v_lshlrev_b32 v216, 6, v216
    v_xor_b32 v218, v218, v216
    v_min_u32 v217, 63, v217
    s_movk_i32 s27, 8192
    v_mul_lo_u32 v217, v217, s27
    v_add_u32 v208, v217, v218
    s_mul_i32 s27, s24, 4096
    v_lshlrev_b32 v216, 4, v1
    v_add_u32 v216, s27, v216
    v_add_u32 v216, 1024, v216
    v_lshrrev_b32 v217, 9, v216
    v_and_b32 v218, 511, v216
    v_and_b32 v216, 3, v217
    v_lshlrev_b32 v216, 6, v216
    v_xor_b32 v218, v218, v216
    v_min_u32 v217, 63, v217
    s_movk_i32 s27, 8192
    v_mul_lo_u32 v217, v217, s27
    v_add_u32 v209, v217, v218
    s_mul_i32 s27, s24, 4096
    v_lshlrev_b32 v216, 4, v1
    v_add_u32 v216, s27, v216
    v_add_u32 v216, 2048, v216
    v_lshrrev_b32 v217, 9, v216
    v_and_b32 v218, 511, v216
    v_and_b32 v216, 3, v217
    v_lshlrev_b32 v216, 6, v216
    v_xor_b32 v218, v218, v216
    v_min_u32 v217, 63, v217
    s_movk_i32 s27, 8192
    v_mul_lo_u32 v217, v217, s27
    v_add_u32 v210, v217, v218
    s_mul_i32 s27, s24, 4096
    v_lshlrev_b32 v216, 4, v1
    v_add_u32 v216, s27, v216
    v_add_u32 v216, 3072, v216
    v_lshrrev_b32 v217, 9, v216
    v_and_b32 v218, 511, v216
    v_and_b32 v216, 3, v217
    v_lshlrev_b32 v216, 6, v216
    v_xor_b32 v218, v218, v216
    v_min_u32 v217, 63, v217
    s_movk_i32 s27, 8192
    v_mul_lo_u32 v217, v217, s27
    v_add_u32 v211, v217, v218
    v_and_b32 v216, 31, v1
    s_mul_i32 s27, s25, 128
    v_add_u32 v216, s27, v216
    v_lshrrev_b32 v217, 1, v216
    v_and_b32 v217, 7, v217
    v_lshrrev_b32 v218, 5, v1
    v_xor_b32 v217, v217, v218
    v_lshlrev_b32 v216, 7, v216
    v_xor_b32 v218, 0, v217
    v_lshlrev_b32 v218, 4, v218
    v_add_u32 v192, v216, v218
    v_add_u32 v196, 65536, v192
    v_xor_b32 v218, 2, v217
    v_lshlrev_b32 v218, 4, v218
    v_add_u32 v193, v216, v218
    v_add_u32 v197, 65536, v193
    v_xor_b32 v218, 4, v217
    v_lshlrev_b32 v218, 4, v218
    v_add_u32 v194, v216, v218
    v_add_u32 v198, 65536, v194
    v_xor_b32 v218, 6, v217
    v_lshlrev_b32 v218, 4, v218
    v_add_u32 v195, v216, v218
    v_add_u32 v199, 65536, v195
    v_lshrrev_b32 v216, 2, v1
    v_and_b32 v216, 3, v216
    v_lshrrev_b32 v217, 5, v1
    v_lshlrev_b32 v217, 3, v217
    v_add_u32 v217, v217, v216
    s_movk_i32 s27, 512
    v_mul_lo_u32 v217, v217, s27
    v_add_u32 v217, 32768, v217
    v_lshrrev_b32 v218, 4, v1
    v_and_b32 v218, 1, v218
    v_lshlrev_b32 v218, 5, v218
    v_add_u32 v217, v217, v218
    v_and_b32 v218, 3, v1
    v_lshlrev_b32 v218, 3, v218
    v_add_u32 v217, v217, v218
    s_mul_i32 s27, s26, 2
    s_add_u32 s28, s27, 0
    v_xor_b32 v218, s28, v216
    v_lshlrev_b32 v218, 6, v218
    v_add_u32 v200, v217, v218
    v_add_u32 v202, 65536, v200
    s_add_u32 s28, s27, 1
    v_xor_b32 v218, s28, v216
    v_lshlrev_b32 v218, 6, v218
    v_add_u32 v201, v217, v218
    v_add_u32 v203, 65536, v201
    v_and_b32 v216, 31, v1
    s_mul_i32 s27, s25, 128
    s_add_u32 s27, s27, 0
    v_add_u32 v216, s27, v216
    s_mov_b32 s27, 8192
    v_mul_lo_u32 v217, v216, s27
    v_cmp_gt_u32 vcc, 240, v216
    v_mov_b32 v218, 0x80000000
    s_nop 0
    v_cndmask_b32 v212, v218, v217, vcc
    v_and_b32 v216, 31, v1
    s_mul_i32 s27, s25, 128
    s_add_u32 s27, s27, 32
    v_add_u32 v216, s27, v216
    s_mov_b32 s27, 8192
    v_mul_lo_u32 v217, v216, s27
    v_cmp_gt_u32 vcc, 240, v216
    v_mov_b32 v218, 0x80000000
    s_nop 0
    v_cndmask_b32 v213, v218, v217, vcc
    v_and_b32 v216, 31, v1
    s_mul_i32 s27, s25, 128
    s_add_u32 s27, s27, 64
    v_add_u32 v216, s27, v216
    s_mov_b32 s27, 8192
    v_mul_lo_u32 v217, v216, s27
    v_cmp_gt_u32 vcc, 240, v216
    v_mov_b32 v218, 0x80000000
    s_nop 0
    v_cndmask_b32 v214, v218, v217, vcc
    v_and_b32 v216, 31, v1
    s_mul_i32 s27, s25, 128
    s_add_u32 s27, s27, 96
    v_add_u32 v216, s27, v216
    s_mov_b32 s27, 8192
    v_mul_lo_u32 v217, v216, s27
    v_cmp_gt_u32 vcc, 240, v216
    v_mov_b32 v218, 0x80000000
    s_nop 0
    v_cndmask_b32 v215, v218, v217, vcc
    v_mov_b32 v16, 0
    v_mov_b32 v17, 0
    v_mov_b32 v18, 0
    v_mov_b32 v19, 0
    v_mov_b32 v20, 0
    v_mov_b32 v21, 0
    v_mov_b32 v22, 0
    v_mov_b32 v23, 0
    v_mov_b32 v24, 0
    v_mov_b32 v25, 0
    v_mov_b32 v26, 0
    v_mov_b32 v27, 0
    v_mov_b32 v28, 0
    v_mov_b32 v29, 0
    v_mov_b32 v30, 0
    v_mov_b32 v31, 0
    v_mov_b32 v32, 0
    v_mov_b32 v33, 0
    v_mov_b32 v34, 0
    v_mov_b32 v35, 0
    v_mov_b32 v36, 0
    v_mov_b32 v37, 0
    v_mov_b32 v38, 0
    v_mov_b32 v39, 0
    v_mov_b32 v40, 0
    v_mov_b32 v41, 0
    v_mov_b32 v42, 0
    v_mov_b32 v43, 0
    v_mov_b32 v44, 0
    v_mov_b32 v45, 0
    v_mov_b32 v46, 0
    v_mov_b32 v47, 0
    v_mov_b32 v48, 0
    v_mov_b32 v49, 0
    v_mov_b32 v50, 0
    v_mov_b32 v51, 0
    v_mov_b32 v52, 0
    v_mov_b32 v53, 0
    v_mov_b32 v54, 0
    v_mov_b32 v55, 0
    v_mov_b32 v56, 0
    v_mov_b32 v57, 0
    v_mov_b32 v58, 0
    v_mov_b32 v59, 0
    v_mov_b32 v60, 0
    v_mov_b32 v61, 0
    v_mov_b32 v62, 0
    v_mov_b32 v63, 0
    v_mov_b32 v64, 0
    v_mov_b32 v65, 0
    v_mov_b32 v66, 0
    v_mov_b32 v67, 0
    v_mov_b32 v68, 0
    v_mov_b32 v69, 0
    v_mov_b32 v70, 0
    v_mov_b32 v71, 0
    v_mov_b32 v72, 0
    v_mov_b32 v73, 0
    v_mov_b32 v74, 0
    v_mov_b32 v75, 0
    v_mov_b32 v76, 0
    v_mov_b32 v77, 0
    v_mov_b32 v78, 0
    v_mov_b32 v79, 0
    v_mov_b32 v80, 0
    v_mov_b32 v81, 0
    v_mov_b32 v82, 0
    v_mov_b32 v83, 0
    v_mov_b32 v84, 0
    v_mov_b32 v85, 0
    v_mov_b32 v86, 0
    v_mov_b32 v87, 0
    v_mov_b32 v88, 0
    v_mov_b32 v89, 0
    v_mov_b32 v90, 0
    v_mov_b32 v91, 0
    v_mov_b32 v92, 0
    v_mov_b32 v93, 0
    v_mov_b32 v94, 0
    v_mov_b32 v95, 0
    v_mov_b32 v96, 0
    v_mov_b32 v97, 0
    v_mov_b32 v98, 0
    v_mov_b32 v99, 0
    v_mov_b32 v100, 0
    v_mov_b32 v101, 0
    v_mov_b32 v102, 0
    v_mov_b32 v103, 0
    v_mov_b32 v104, 0
    v_mov_b32 v105, 0
    v_mov_b32 v106, 0
    v_mov_b32 v107, 0
    v_mov_b32 v108, 0
    v_mov_b32 v109, 0
    v_mov_b32 v110, 0
    v_mov_b32 v111, 0
    v_mov_b32 v112, 0
    v_mov_b32 v113, 0
    v_mov_b32 v114, 0
    v_mov_b32 v115, 0
    v_mov_b32 v116, 0
    v_mov_b32 v117, 0
    v_mov_b32 v118, 0
    v_mov_b32 v119, 0
    v_mov_b32 v120, 0
    v_mov_b32 v121, 0
    v_mov_b32 v122, 0
    v_mov_b32 v123, 0
    v_mov_b32 v124, 0
    v_mov_b32 v125, 0
    v_mov_b32 v126, 0
    v_mov_b32 v127, 0
    v_mov_b32 v128, 0
    v_mov_b32 v129, 0
    v_mov_b32 v130, 0
    v_mov_b32 v131, 0
    v_mov_b32 v132, 0
    v_mov_b32 v133, 0
    v_mov_b32 v134, 0
    v_mov_b32 v135, 0
    v_mov_b32 v136, 0
    v_mov_b32 v137, 0
    v_mov_b32 v138, 0
    v_mov_b32 v139, 0
    v_mov_b32 v140, 0
    v_mov_b32 v141, 0
    v_mov_b32 v142, 0
    v_mov_b32 v143, 0
    s_mul_i32 s29, s24, 4096
    s_mul_i32 s30, s24, 4096
    s_add_u32 s30, s30, 32768
    s_mov_b32 s31, 0
    s_mov_b32 s32, 0
    s_add_u32 m0, s29, 0
    s_nop 0
    buffer_load_dwordx4 v204, s[12:15], s31 offen lds
    s_add_u32 m0, s29, 1024
    s_nop 0
    buffer_load_dwordx4 v205, s[12:15], s31 offen lds
    s_add_u32 m0, s29, 2048
    s_nop 0
    buffer_load_dwordx4 v206, s[12:15], s31 offen lds
    s_add_u32 m0, s29, 3072
    s_nop 0
    buffer_load_dwordx4 v207, s[12:15], s31 offen lds
    s_add_u32 m0, s30, 0
    s_nop 0
    buffer_load_dwordx4 v208, s[16:19], s32 offen lds
    s_add_u32 m0, s30, 1024
    s_nop 0
    buffer_load_dwordx4 v209, s[16:19], s32 offen lds
    s_add_u32 m0, s30, 2048
    s_nop 0
    buffer_load_dwordx4 v210, s[16:19], s32 offen lds
    s_add_u32 m0, s30, 3072
    s_nop 0
    buffer_load_dwordx4 v211, s[16:19], s32 offen lds
    s_add_u32 s31, s31, 128
    s_add_u32 s32, s32, 524288
    s_waitcnt vmcnt(0)
    s_barrier
    s_add_u32 m0, s29, 65536
    s_nop 0
    buffer_load_dwordx4 v204, s[12:15], s31 offen lds
    s_add_u32 m0, s29, 66560
    s_nop 0
    buffer_load_dwordx4 v205, s[12:15], s31 offen lds
    s_add_u32 m0, s29, 67584
    s_nop 0
    buffer_load_dwordx4 v206, s[12:15], s31 offen lds
    s_add_u32 m0, s29, 68608
    s_nop 0
    buffer_load_dwordx4 v207, s[12:15], s31 offen lds
    s_add_u32 m0, s30, 65536
    s_nop 0
    buffer_load_dwordx4 v208, s[16:19], s32 offen lds
    s_add_u32 m0, s30, 66560
    s_nop 0
    buffer_load_dwordx4 v209, s[16:19], s32 offen lds
    s_add_u32 m0, s30, 67584
    s_nop 0
    buffer_load_dwordx4 v210, s[16:19], s32 offen lds
    s_add_u32 m0, s30, 68608
    s_nop 0
    buffer_load_dwordx4 v211, s[16:19], s32 offen lds
    s_add_u32 s31, s31, 128
    s_add_u32 s32, s32, 524288
    ds_read_b128 v[144:147], v192 offset:0
    ds_read_b128 v[148:151], v192 offset:4096
    ds_read_b128 v[152:155], v192 offset:8192
    ds_read_b128 v[156:159], v192 offset:12288
    ds_read_b64_tr_b16 v[160:161], v200 offset:0
    ds_read_b64_tr_b16 v[162:163], v200 offset:2048
    ds_read_b64_tr_b16 v[164:165], v201 offset:0
    ds_read_b64_tr_b16 v[166:167], v201 offset:2048
    ds_read_b128 v[168:171], v193 offset:0
    ds_read_b128 v[172:175], v193 offset:4096
    ds_read_b128 v[176:179], v193 offset:8192
    ds_read_b128 v[180:183], v193 offset:12288
    ds_read_b64_tr_b16 v[184:185], v200 offset:8192
    ds_read_b64_tr_b16 v[186:187], v200 offset:10240
    ds_read_b64_tr_b16 v[188:189], v201 offset:8192
    ds_read_b64_tr_b16 v[190:191], v201 offset:10240
    s_waitcnt lgkmcnt(8)
    v_mfma_f32_32x32x16_bf16 v[16:31], v[160:163], v[144:147], v[16:31]
    v_mfma_f32_32x32x16_bf16 v[32:47], v[164:167], v[144:147], v[32:47]
    v_mfma_f32_32x32x16_bf16 v[48:63], v[160:163], v[148:151], v[48:63]
    v_mfma_f32_32x32x16_bf16 v[64:79], v[164:167], v[148:151], v[64:79]
    v_mfma_f32_32x32x16_bf16 v[80:95], v[160:163], v[152:155], v[80:95]
    v_mfma_f32_32x32x16_bf16 v[96:111], v[164:167], v[152:155], v[96:111]
    v_mfma_f32_32x32x16_bf16 v[112:127], v[160:163], v[156:159], v[112:127]
    v_mfma_f32_32x32x16_bf16 v[128:143], v[164:167], v[156:159], v[128:143]
    ds_read_b128 v[144:147], v194 offset:0
    ds_read_b128 v[148:151], v194 offset:4096
    ds_read_b128 v[152:155], v194 offset:8192
    ds_read_b128 v[156:159], v194 offset:12288
    ds_read_b64_tr_b16 v[160:161], v200 offset:16384
    ds_read_b64_tr_b16 v[162:163], v200 offset:18432
    ds_read_b64_tr_b16 v[164:165], v201 offset:16384
    ds_read_b64_tr_b16 v[166:167], v201 offset:18432
    s_waitcnt lgkmcnt(8)
    v_mfma_f32_32x32x16_bf16 v[16:31], v[184:187], v[168:171], v[16:31]
    v_mfma_f32_32x32x16_bf16 v[32:47], v[188:191], v[168:171], v[32:47]
    v_mfma_f32_32x32x16_bf16 v[48:63], v[184:187], v[172:175], v[48:63]
    v_mfma_f32_32x32x16_bf16 v[64:79], v[188:191], v[172:175], v[64:79]
    v_mfma_f32_32x32x16_bf16 v[80:95], v[184:187], v[176:179], v[80:95]
    v_mfma_f32_32x32x16_bf16 v[96:111], v[188:191], v[176:179], v[96:111]
    v_mfma_f32_32x32x16_bf16 v[112:127], v[184:187], v[180:183], v[112:127]
    v_mfma_f32_32x32x16_bf16 v[128:143], v[188:191], v[180:183], v[128:143]
    ds_read_b128 v[168:171], v195 offset:0
    ds_read_b128 v[172:175], v195 offset:4096
    ds_read_b128 v[176:179], v195 offset:8192
    ds_read_b128 v[180:183], v195 offset:12288
    ds_read_b64_tr_b16 v[184:185], v200 offset:24576
    ds_read_b64_tr_b16 v[186:187], v200 offset:26624
    ds_read_b64_tr_b16 v[188:189], v201 offset:24576
    ds_read_b64_tr_b16 v[190:191], v201 offset:26624
    s_waitcnt lgkmcnt(8)
    v_mfma_f32_32x32x16_bf16 v[16:31], v[160:163], v[144:147], v[16:31]
    v_mfma_f32_32x32x16_bf16 v[32:47], v[164:167], v[144:147], v[32:47]
    v_mfma_f32_32x32x16_bf16 v[48:63], v[160:163], v[148:151], v[48:63]
    v_mfma_f32_32x32x16_bf16 v[64:79], v[164:167], v[148:151], v[64:79]
    v_mfma_f32_32x32x16_bf16 v[80:95], v[160:163], v[152:155], v[80:95]
    v_mfma_f32_32x32x16_bf16 v[96:111], v[164:167], v[152:155], v[96:111]
    v_mfma_f32_32x32x16_bf16 v[112:127], v[160:163], v[156:159], v[112:127]
    v_mfma_f32_32x32x16_bf16 v[128:143], v[164:167], v[156:159], v[128:143]
    s_waitcnt lgkmcnt(0)
    v_mfma_f32_32x32x16_bf16 v[16:31], v[184:187], v[168:171], v[16:31]
    v_mfma_f32_32x32x16_bf16 v[32:47], v[188:191], v[168:171], v[32:47]
    v_mfma_f32_32x32x16_bf16 v[48:63], v[184:187], v[172:175], v[48:63]
    v_mfma_f32_32x32x16_bf16 v[64:79], v[188:191], v[172:175], v[64:79]
    v_mfma_f32_32x32x16_bf16 v[80:95], v[184:187], v[176:179], v[80:95]
    v_mfma_f32_32x32x16_bf16 v[96:111], v[188:191], v[176:179], v[96:111]
    v_mfma_f32_32x32x16_bf16 v[112:127], v[184:187], v[180:183], v[112:127]
    v_mfma_f32_32x32x16_bf16 v[128:143], v[188:191], v[180:183], v[128:143]
    s_waitcnt vmcnt(0)
    s_barrier
    s_add_u32 m0, s29, 0
    s_nop 0
    buffer_load_dwordx4 v204, s[12:15], s31 offen lds
    s_add_u32 m0, s29, 1024
    s_nop 0
    buffer_load_dwordx4 v205, s[12:15], s31 offen lds
    s_add_u32 m0, s29, 2048
    s_nop 0
    buffer_load_dwordx4 v206, s[12:15], s31 offen lds
    s_add_u32 m0, s29, 3072
    s_nop 0
    buffer_load_dwordx4 v207, s[12:15], s31 offen lds
    s_add_u32 m0, s30, 0
    s_nop 0
    buffer_load_dwordx4 v208, s[16:19], s32 offen lds
    s_add_u32 m0, s30, 1024
    s_nop 0
    buffer_load_dwordx4 v209, s[16:19], s32 offen lds
    s_add_u32 m0, s30, 2048
    s_nop 0
    buffer_load_dwordx4 v210, s[16:19], s32 offen lds
    s_add_u32 m0, s30, 3072
    s_nop 0
    buffer_load_dwordx4 v211, s[16:19], s32 offen lds
    s_add_u32 s31, s31, 128
    s_add_u32 s32, s32, 524288
    ds_read_b128 v[144:147], v196 offset:0
    ds_read_b128 v[148:151], v196 offset:4096
    ds_read_b128 v[152:155], v196 offset:8192
    ds_read_b128 v[156:159], v196 offset:12288
    ds_read_b64_tr_b16 v[160:161], v202 offset:0
    ds_read_b64_tr_b16 v[162:163], v202 offset:2048
    ds_read_b64_tr_b16 v[164:165], v203 offset:0
    ds_read_b64_tr_b16 v[166:167], v203 offset:2048
    ds_read_b128 v[168:171], v197 offset:0
    ds_read_b128 v[172:175], v197 offset:4096
    ds_read_b128 v[176:179], v197 offset:8192
    ds_read_b128 v[180:183], v197 offset:12288
    ds_read_b64_tr_b16 v[184:185], v202 offset:8192
    ds_read_b64_tr_b16 v[186:187], v202 offset:10240
    ds_read_b64_tr_b16 v[188:189], v203 offset:8192
    ds_read_b64_tr_b16 v[190:191], v203 offset:10240
    s_waitcnt lgkmcnt(8)
    v_mfma_f32_32x32x16_bf16 v[16:31], v[160:163], v[144:147], v[16:31]
    v_mfma_f32_32x32x16_bf16 v[32:47], v[164:167], v[144:147], v[32:47]
    v_mfma_f32_32x32x16_bf16 v[48:63], v[160:163], v[148:151], v[48:63]
    v_mfma_f32_32x32x16_bf16 v[64:79], v[164:167], v[148:151], v[64:79]
    v_mfma_f32_32x32x16_bf16 v[80:95], v[160:163], v[152:155], v[80:95]
    v_mfma_f32_32x32x16_bf16 v[96:111], v[164:167], v[152:155], v[96:111]
    v_mfma_f32_32x32x16_bf16 v[112:127], v[160:163], v[156:159], v[112:127]
    v_mfma_f32_32x32x16_bf16 v[128:143], v[164:167], v[156:159], v[128:143]
    ds_read_b128 v[144:147], v198 offset:0
    ds_read_b128 v[148:151], v198 offset:4096
    ds_read_b128 v[152:155], v198 offset:8192
    ds_read_b128 v[156:159], v198 offset:12288
    ds_read_b64_tr_b16 v[160:161], v202 offset:16384
    ds_read_b64_tr_b16 v[162:163], v202 offset:18432
    ds_read_b64_tr_b16 v[164:165], v203 offset:16384
    ds_read_b64_tr_b16 v[166:167], v203 offset:18432
    s_waitcnt lgkmcnt(8)
    v_mfma_f32_32x32x16_bf16 v[16:31], v[184:187], v[168:171], v[16:31]
    v_mfma_f32_32x32x16_bf16 v[32:47], v[188:191], v[168:171], v[32:47]
    v_mfma_f32_32x32x16_bf16 v[48:63], v[184:187], v[172:175], v[48:63]
    v_mfma_f32_32x32x16_bf16 v[64:79], v[188:191], v[172:175], v[64:79]
    v_mfma_f32_32x32x16_bf16 v[80:95], v[184:187], v[176:179], v[80:95]
    v_mfma_f32_32x32x16_bf16 v[96:111], v[188:191], v[176:179], v[96:111]
    v_mfma_f32_32x32x16_bf16 v[112:127], v[184:187], v[180:183], v[112:127]
    v_mfma_f32_32x32x16_bf16 v[128:143], v[188:191], v[180:183], v[128:143]
    ds_read_b128 v[168:171], v199 offset:0
    ds_read_b128 v[172:175], v199 offset:4096
    ds_read_b128 v[176:179], v199 offset:8192
    ds_read_b128 v[180:183], v199 offset:12288
    ds_read_b64_tr_b16 v[184:185], v202 offset:24576
    ds_read_b64_tr_b16 v[186:187], v202 offset:26624
    ds_read_b64_tr_b16 v[188:189], v203 offset:24576
    ds_read_b64_tr_b16 v[190:191], v203 offset:26624
    s_waitcnt lgkmcnt(8)
    v_mfma_f32_32x32x16_bf16 v[16:31], v[160:163], v[144:147], v[16:31]
    v_mfma_f32_32x32x16_bf16 v[32:47], v[164:167], v[144:147], v[32:47]
    v_mfma_f32_32x32x16_bf16 v[48:63], v[160:163], v[148:151], v[48:63]
    v_mfma_f32_32x32x16_bf16 v[64:79], v[164:167], v[148:151], v[64:79]
    v_mfma_f32_32x32x16_bf16 v[80:95], v[160:163], v[152:155], v[80:95]
    v_mfma_f32_32x32x16_bf16 v[96:111], v[164:167], v[152:155], v[96:111]
    v_mfma_f32_32x32x16_bf16 v[112:127], v[160:163], v[156:159], v[112:127]
    v_mfma_f32_32x32x16_bf16 v[128:143], v[164:167], v[156:159], v[128:143]
    s_waitcnt lgkmcnt(0)
    v_mfma_f32_32x32x16_bf16 v[16:31], v[184:187], v[168:171], v[16:31]
    v_mfma_f32_32x32x16_bf16 v[32:47], v[188:191], v[168:171], v[32:47]
    v_mfma_f32_32x32x16_bf16 v[48:63], v[184:187], v[172:175], v[48:63]
    v_mfma_f32_32x32x16_bf16 v[64:79], v[188:191], v[172:175], v[64:79]
    v_mfma_f32_32x32x16_bf16 v[80:95], v[184:187], v[176:179], v[80:95]
    v_mfma_f32_32x32x16_bf16 v[96:111], v[188:191], v[176:179], v[96:111]
    v_mfma_f32_32x32x16_bf16 v[112:127], v[184:187], v[180:183], v[112:127]
    v_mfma_f32_32x32x16_bf16 v[128:143], v[188:191], v[180:183], v[128:143]
    s_waitcnt vmcnt(0)
    s_barrier
    s_add_u32 m0, s29, 65536
    s_nop 0
    buffer_load_dwordx4 v204, s[12:15], s31 offen lds
    s_add_u32 m0, s29, 66560
    s_nop 0
    buffer_load_dwordx4 v205, s[12:15], s31 offen lds
    s_add_u32 m0, s29, 67584
    s_nop 0
    buffer_load_dwordx4 v206, s[12:15], s31 offen lds
    s_add_u32 m0, s29, 68608
    s_nop 0
    buffer_load_dwordx4 v207, s[12:15], s31 offen lds
    s_add_u32 m0, s30, 65536
    s_nop 0
    buffer_load_dwordx4 v208, s[16:19], s32 offen lds
    s_add_u32 m0, s30, 66560
    s_nop 0
    buffer_load_dwordx4 v209, s[16:19], s32 offen lds
    s_add_u32 m0, s30, 67584
    s_nop 0
    buffer_load_dwordx4 v210, s[16:19], s32 offen lds
    s_add_u32 m0, s30, 68608
    s_nop 0
    buffer_load_dwordx4 v211, s[16:19], s32 offen lds
    s_add_u32 s31, s31, 128
    s_add_u32 s32, s32, 524288
    ds_read_b128 v[144:147], v192 offset:0
    ds_read_b128 v[148:151], v192 offset:4096
    ds_read_b128 v[152:155], v192 offset:8192
    ds_read_b128 v[156:159], v192 offset:12288
    ds_read_b64_tr_b16 v[160:161], v200 offset:0
    ds_read_b64_tr_b16 v[162:163], v200 offset:2048
    ds_read_b64_tr_b16 v[164:165], v201 offset:0
    ds_read_b64_tr_b16 v[166:167], v201 offset:2048
    ds_read_b128 v[168:171], v193 offset:0
    ds_read_b128 v[172:175], v193 offset:4096
    ds_read_b128 v[176:179], v193 offset:8192
    ds_read_b128 v[180:183], v193 offset:12288
    ds_read_b64_tr_b16 v[184:185], v200 offset:8192
    ds_read_b64_tr_b16 v[186:187], v200 offset:10240
    ds_read_b64_tr_b16 v[188:189], v201 offset:8192
    ds_read_b64_tr_b16 v[190:191], v201 offset:10240
    s_waitcnt lgkmcnt(8)
    v_mfma_f32_32x32x16_bf16 v[16:31], v[160:163], v[144:147], v[16:31]
    v_mfma_f32_32x32x16_bf16 v[32:47], v[164:167], v[144:147], v[32:47]
    v_mfma_f32_32x32x16_bf16 v[48:63], v[160:163], v[148:151], v[48:63]
    v_mfma_f32_32x32x16_bf16 v[64:79], v[164:167], v[148:151], v[64:79]
    v_mfma_f32_32x32x16_bf16 v[80:95], v[160:163], v[152:155], v[80:95]
    v_mfma_f32_32x32x16_bf16 v[96:111], v[164:167], v[152:155], v[96:111]
    v_mfma_f32_32x32x16_bf16 v[112:127], v[160:163], v[156:159], v[112:127]
    v_mfma_f32_32x32x16_bf16 v[128:143], v[164:167], v[156:159], v[128:143]
    ds_read_b128 v[144:147], v194 offset:0
    ds_read_b128 v[148:151], v194 offset:4096
    ds_read_b128 v[152:155], v194 offset:8192
    ds_read_b128 v[156:159], v194 offset:12288
    ds_read_b64_tr_b16 v[160:161], v200 offset:16384
    ds_read_b64_tr_b16 v[162:163], v200 offset:18432
    ds_read_b64_tr_b16 v[164:165], v201 offset:16384
    ds_read_b64_tr_b16 v[166:167], v201 offset:18432
    s_waitcnt lgkmcnt(8)
    v_mfma_f32_32x32x16_bf16 v[16:31], v[184:187], v[168:171], v[16:31]
    v_mfma_f32_32x32x16_bf16 v[32:47], v[188:191], v[168:171], v[32:47]
    v_mfma_f32_32x32x16_bf16 v[48:63], v[184:187], v[172:175], v[48:63]
    v_mfma_f32_32x32x16_bf16 v[64:79], v[188:191], v[172:175], v[64:79]
    v_mfma_f32_32x32x16_bf16 v[80:95], v[184:187], v[176:179], v[80:95]
    v_mfma_f32_32x32x16_bf16 v[96:111], v[188:191], v[176:179], v[96:111]
    v_mfma_f32_32x32x16_bf16 v[112:127], v[184:187], v[180:183], v[112:127]
    v_mfma_f32_32x32x16_bf16 v[128:143], v[188:191], v[180:183], v[128:143]
    ds_read_b128 v[168:171], v195 offset:0
    ds_read_b128 v[172:175], v195 offset:4096
    ds_read_b128 v[176:179], v195 offset:8192
    ds_read_b128 v[180:183], v195 offset:12288
    ds_read_b64_tr_b16 v[184:185], v200 offset:24576
    ds_read_b64_tr_b16 v[186:187], v200 offset:26624
    ds_read_b64_tr_b16 v[188:189], v201 offset:24576
    ds_read_b64_tr_b16 v[190:191], v201 offset:26624
    s_waitcnt lgkmcnt(8)
    v_mfma_f32_32x32x16_bf16 v[16:31], v[160:163], v[144:147], v[16:31]
    v_mfma_f32_32x32x16_bf16 v[32:47], v[164:167], v[144:147], v[32:47]
    v_mfma_f32_32x32x16_bf16 v[48:63], v[160:163], v[148:151], v[48:63]
    v_mfma_f32_32x32x16_bf16 v[64:79], v[164:167], v[148:151], v[64:79]
    v_mfma_f32_32x32x16_bf16 v[80:95], v[160:163], v[152:155], v[80:95]
    v_mfma_f32_32x32x16_bf16 v[96:111], v[164:167], v[152:155], v[96:111]
    v_mfma_f32_32x32x16_bf16 v[112:127], v[160:163], v[156:159], v[112:127]
    v_mfma_f32_32x32x16_bf16 v[128:143], v[164:167], v[156:159], v[128:143]
    s_waitcnt lgkmcnt(0)
    v_mfma_f32_32x32x16_bf16 v[16:31], v[184:187], v[168:171], v[16:31]
    v_mfma_f32_32x32x16_bf16 v[32:47], v[188:191], v[168:171], v[32:47]
    v_mfma_f32_32x32x16_bf16 v[48:63], v[184:187], v[172:175], v[48:63]
    v_mfma_f32_32x32x16_bf16 v[64:79], v[188:191], v[172:175], v[64:79]
    v_mfma_f32_32x32x16_bf16 v[80:95], v[184:187], v[176:179], v[80:95]
    v_mfma_f32_32x32x16_bf16 v[96:111], v[188:191], v[176:179], v[96:111]
    v_mfma_f32_32x32x16_bf16 v[112:127], v[184:187], v[180:183], v[112:127]
    v_mfma_f32_32x32x16_bf16 v[128:143], v[188:191], v[180:183], v[128:143]
    s_waitcnt vmcnt(0)
    s_barrier
    s_add_u32 m0, s29, 0
    s_nop 0
    buffer_load_dwordx4 v204, s[12:15], s31 offen lds
    s_add_u32 m0, s29, 1024
    s_nop 0
    buffer_load_dwordx4 v205, s[12:15], s31 offen lds
    s_add_u32 m0, s29, 2048
    s_nop 0
    buffer_load_dwordx4 v206, s[12:15], s31 offen lds
    s_add_u32 m0, s29, 3072
    s_nop 0
    buffer_load_dwordx4 v207, s[12:15], s31 offen lds
    s_add_u32 m0, s30, 0
    s_nop 0
    buffer_load_dwordx4 v208, s[16:19], s32 offen lds
    s_add_u32 m0, s30, 1024
    s_nop 0
    buffer_load_dwordx4 v209, s[16:19], s32 offen lds
    s_add_u32 m0, s30, 2048
    s_nop 0
    buffer_load_dwordx4 v210, s[16:19], s32 offen lds
    s_add_u32 m0, s30, 3072
    s_nop 0
    buffer_load_dwordx4 v211, s[16:19], s32 offen lds
    s_add_u32 s31, s31, 128
    s_add_u32 s32, s32, 524288
    ds_read_b128 v[144:147], v196 offset:0
    ds_read_b128 v[148:151], v196 offset:4096
    ds_read_b128 v[152:155], v196 offset:8192
    ds_read_b128 v[156:159], v196 offset:12288
    ds_read_b64_tr_b16 v[160:161], v202 offset:0
    ds_read_b64_tr_b16 v[162:163], v202 offset:2048
    ds_read_b64_tr_b16 v[164:165], v203 offset:0
    ds_read_b64_tr_b16 v[166:167], v203 offset:2048
    ds_read_b128 v[168:171], v197 offset:0
    ds_read_b128 v[172:175], v197 offset:4096
    ds_read_b128 v[176:179], v197 offset:8192
    ds_read_b128 v[180:183], v197 offset:12288
    ds_read_b64_tr_b16 v[184:185], v202 offset:8192
    ds_read_b64_tr_b16 v[186:187], v202 offset:10240
    ds_read_b64_tr_b16 v[188:189], v203 offset:8192
    ds_read_b64_tr_b16 v[190:191], v203 offset:10240
    s_waitcnt lgkmcnt(8)
    v_mfma_f32_32x32x16_bf16 v[16:31], v[160:163], v[144:147], v[16:31]
    v_mfma_f32_32x32x16_bf16 v[32:47], v[164:167], v[144:147], v[32:47]
    v_mfma_f32_32x32x16_bf16 v[48:63], v[160:163], v[148:151], v[48:63]
    v_mfma_f32_32x32x16_bf16 v[64:79], v[164:167], v[148:151], v[64:79]
    v_mfma_f32_32x32x16_bf16 v[80:95], v[160:163], v[152:155], v[80:95]
    v_mfma_f32_32x32x16_bf16 v[96:111], v[164:167], v[152:155], v[96:111]
    v_mfma_f32_32x32x16_bf16 v[112:127], v[160:163], v[156:159], v[112:127]
    v_mfma_f32_32x32x16_bf16 v[128:143], v[164:167], v[156:159], v[128:143]
    ds_read_b128 v[144:147], v198 offset:0
    ds_read_b128 v[148:151], v198 offset:4096
    ds_read_b128 v[152:155], v198 offset:8192
    ds_read_b128 v[156:159], v198 offset:12288
    ds_read_b64_tr_b16 v[160:161], v202 offset:16384
    ds_read_b64_tr_b16 v[162:163], v202 offset:18432
    ds_read_b64_tr_b16 v[164:165], v203 offset:16384
    ds_read_b64_tr_b16 v[166:167], v203 offset:18432
    s_waitcnt lgkmcnt(8)
    v_mfma_f32_32x32x16_bf16 v[16:31], v[184:187], v[168:171], v[16:31]
    v_mfma_f32_32x32x16_bf16 v[32:47], v[188:191], v[168:171], v[32:47]
    v_mfma_f32_32x32x16_bf16 v[48:63], v[184:187], v[172:175], v[48:63]
    v_mfma_f32_32x32x16_bf16 v[64:79], v[188:191], v[172:175], v[64:79]
    v_mfma_f32_32x32x16_bf16 v[80:95], v[184:187], v[176:179], v[80:95]
    v_mfma_f32_32x32x16_bf16 v[96:111], v[188:191], v[176:179], v[96:111]
    v_mfma_f32_32x32x16_bf16 v[112:127], v[184:187], v[180:183], v[112:127]
    v_mfma_f32_32x32x16_bf16 v[128:143], v[188:191], v[180:183], v[128:143]
    ds_read_b128 v[168:171], v199 offset:0
    ds_read_b128 v[172:175], v199 offset:4096
    ds_read_b128 v[176:179], v199 offset:8192
    ds_read_b128 v[180:183], v199 offset:12288
    ds_read_b64_tr_b16 v[184:185], v202 offset:24576
    ds_read_b64_tr_b16 v[186:187], v202 offset:26624
    ds_read_b64_tr_b16 v[188:189], v203 offset:24576
    ds_read_b64_tr_b16 v[190:191], v203 offset:26624
    s_waitcnt lgkmcnt(8)
    v_mfma_f32_32x32x16_bf16 v[16:31], v[160:163], v[144:147], v[16:31]
    v_mfma_f32_32x32x16_bf16 v[32:47], v[164:167], v[144:147], v[32:47]
    v_mfma_f32_32x32x16_bf16 v[48:63], v[160:163], v[148:151], v[48:63]
    v_mfma_f32_32x32x16_bf16 v[64:79], v[164:167], v[148:151], v[64:79]
    v_mfma_f32_32x32x16_bf16 v[80:95], v[160:163], v[152:155], v[80:95]
    v_mfma_f32_32x32x16_bf16 v[96:111], v[164:167], v[152:155], v[96:111]
    v_mfma_f32_32x32x16_bf16 v[112:127], v[160:163], v[156:159], v[112:127]
    v_mfma_f32_32x32x16_bf16 v[128:143], v[164:167], v[156:159], v[128:143]
    s_waitcnt lgkmcnt(0)
    v_mfma_f32_32x32x16_bf16 v[16:31], v[184:187], v[168:171], v[16:31]
    v_mfma_f32_32x32x16_bf16 v[32:47], v[188:191], v[168:171], v[32:47]
    v_mfma_f32_32x32x16_bf16 v[48:63], v[184:187], v[172:175], v[48:63]
    v_mfma_f32_32x32x16_bf16 v[64:79], v[188:191], v[172:175], v[64:79]
    v_mfma_f32_32x32x16_bf16 v[80:95], v[184:187], v[176:179], v[80:95]
    v_mfma_f32_32x32x16_bf16 v[96:111], v[188:191], v[176:179], v[96:111]
    v_mfma_f32_32x32x16_bf16 v[112:127], v[184:187], v[180:183], v[112:127]
    v_mfma_f32_32x32x16_bf16 v[128:143], v[188:191], v[180:183], v[128:143]
    s_waitcnt vmcnt(0)
    s_barrier
    s_add_u32 m0, s29, 65536
    s_nop 0
    buffer_load_dwordx4 v204, s[12:15], s31 offen lds
    s_add_u32 m0, s29, 66560
    s_nop 0
    buffer_load_dwordx4 v205, s[12:15], s31 offen lds
    s_add_u32 m0, s29, 67584
    s_nop 0
    buffer_load_dwordx4 v206, s[12:15], s31 offen lds
    s_add_u32 m0, s29, 68608
    s_nop 0
    buffer_load_dwordx4 v207, s[12:15], s31 offen lds
    s_add_u32 m0, s30, 65536
    s_nop 0
    buffer_load_dwordx4 v208, s[16:19], s32 offen lds
    s_add_u32 m0, s30, 66560
    s_nop 0
    buffer_load_dwordx4 v209, s[16:19], s32 offen lds
    s_add_u32 m0, s30, 67584
    s_nop 0
    buffer_load_dwordx4 v210, s[16:19], s32 offen lds
    s_add_u32 m0, s30, 68608
    s_nop 0
    buffer_load_dwordx4 v211, s[16:19], s32 offen lds
    s_add_u32 s31, s31, 128
    s_add_u32 s32, s32, 524288
    ds_read_b128 v[144:147], v192 offset:0
    ds_read_b128 v[148:151], v192 offset:4096
    ds_read_b128 v[152:155], v192 offset:8192
    ds_read_b128 v[156:159], v192 offset:12288
    ds_read_b64_tr_b16 v[160:161], v200 offset:0
    ds_read_b64_tr_b16 v[162:163], v200 offset:2048
    ds_read_b64_tr_b16 v[164:165], v201 offset:0
    ds_read_b64_tr_b16 v[166:167], v201 offset:2048
    ds_read_b128 v[168:171], v193 offset:0
    ds_read_b128 v[172:175], v193 offset:4096
    ds_read_b128 v[176:179], v193 offset:8192
    ds_read_b128 v[180:183], v193 offset:12288
    ds_read_b64_tr_b16 v[184:185], v200 offset:8192
    ds_read_b64_tr_b16 v[186:187], v200 offset:10240
    ds_read_b64_tr_b16 v[188:189], v201 offset:8192
    ds_read_b64_tr_b16 v[190:191], v201 offset:10240
    s_waitcnt lgkmcnt(8)
    v_mfma_f32_32x32x16_bf16 v[16:31], v[160:163], v[144:147], v[16:31]
    v_mfma_f32_32x32x16_bf16 v[32:47], v[164:167], v[144:147], v[32:47]
    v_mfma_f32_32x32x16_bf16 v[48:63], v[160:163], v[148:151], v[48:63]
    v_mfma_f32_32x32x16_bf16 v[64:79], v[164:167], v[148:151], v[64:79]
    v_mfma_f32_32x32x16_bf16 v[80:95], v[160:163], v[152:155], v[80:95]
    v_mfma_f32_32x32x16_bf16 v[96:111], v[164:167], v[152:155], v[96:111]
    v_mfma_f32_32x32x16_bf16 v[112:127], v[160:163], v[156:159], v[112:127]
    v_mfma_f32_32x32x16_bf16 v[128:143], v[164:167], v[156:159], v[128:143]
    ds_read_b128 v[144:147], v194 offset:0
    ds_read_b128 v[148:151], v194 offset:4096
    ds_read_b128 v[152:155], v194 offset:8192
    ds_read_b128 v[156:159], v194 offset:12288
    ds_read_b64_tr_b16 v[160:161], v200 offset:16384
    ds_read_b64_tr_b16 v[162:163], v200 offset:18432
    ds_read_b64_tr_b16 v[164:165], v201 offset:16384
    ds_read_b64_tr_b16 v[166:167], v201 offset:18432
    s_waitcnt lgkmcnt(8)
    v_mfma_f32_32x32x16_bf16 v[16:31], v[184:187], v[168:171], v[16:31]
    v_mfma_f32_32x32x16_bf16 v[32:47], v[188:191], v[168:171], v[32:47]
    v_mfma_f32_32x32x16_bf16 v[48:63], v[184:187], v[172:175], v[48:63]
    v_mfma_f32_32x32x16_bf16 v[64:79], v[188:191], v[172:175], v[64:79]
    v_mfma_f32_32x32x16_bf16 v[80:95], v[184:187], v[176:179], v[80:95]
    v_mfma_f32_32x32x16_bf16 v[96:111], v[188:191], v[176:179], v[96:111]
    v_mfma_f32_32x32x16_bf16 v[112:127], v[184:187], v[180:183], v[112:127]
    v_mfma_f32_32x32x16_bf16 v[128:143], v[188:191], v[180:183], v[128:143]
    ds_read_b128 v[168:171], v195 offset:0
    ds_read_b128 v[172:175], v195 offset:4096
    ds_read_b128 v[176:179], v195 offset:8192
    ds_read_b128 v[180:183], v195 offset:12288
    ds_read_b64_tr_b16 v[184:185], v200 offset:24576
    ds_read_b64_tr_b16 v[186:187], v200 offset:26624
    ds_read_b64_tr_b16 v[188:189], v201 offset:24576
    ds_read_b64_tr_b16 v[190:191], v201 offset:26624
    s_waitcnt lgkmcnt(8)
    v_mfma_f32_32x32x16_bf16 v[16:31], v[160:163], v[144:147], v[16:31]
    v_mfma_f32_32x32x16_bf16 v[32:47], v[164:167], v[144:147], v[32:47]
    v_mfma_f32_32x32x16_bf16 v[48:63], v[160:163], v[148:151], v[48:63]
    v_mfma_f32_32x32x16_bf16 v[64:79], v[164:167], v[148:151], v[64:79]
    v_mfma_f32_32x32x16_bf16 v[80:95], v[160:163], v[152:155], v[80:95]
    v_mfma_f32_32x32x16_bf16 v[96:111], v[164:167], v[152:155], v[96:111]
    v_mfma_f32_32x32x16_bf16 v[112:127], v[160:163], v[156:159], v[112:127]
    v_mfma_f32_32x32x16_bf16 v[128:143], v[164:167], v[156:159], v[128:143]
    s_waitcnt lgkmcnt(0)
    v_mfma_f32_32x32x16_bf16 v[16:31], v[184:187], v[168:171], v[16:31]
    v_mfma_f32_32x32x16_bf16 v[32:47], v[188:191], v[168:171], v[32:47]
    v_mfma_f32_32x32x16_bf16 v[48:63], v[184:187], v[172:175], v[48:63]
    v_mfma_f32_32x32x16_bf16 v[64:79], v[188:191], v[172:175], v[64:79]
    v_mfma_f32_32x32x16_bf16 v[80:95], v[184:187], v[176:179], v[80:95]
    v_mfma_f32_32x32x16_bf16 v[96:111], v[188:191], v[176:179], v[96:111]
    v_mfma_f32_32x32x16_bf16 v[112:127], v[184:187], v[180:183], v[112:127]
    v_mfma_f32_32x32x16_bf16 v[128:143], v[188:191], v[180:183], v[128:143]
    s_waitcnt vmcnt(0)
    s_barrier
    s_add_u32 m0, s29, 0
    s_nop 0
    buffer_load_dwordx4 v204, s[12:15], s31 offen lds
    s_add_u32 m0, s29, 1024
    s_nop 0
    buffer_load_dwordx4 v205, s[12:15], s31 offen lds
    s_add_u32 m0, s29, 2048
    s_nop 0
    buffer_load_dwordx4 v206, s[12:15], s31 offen lds
    s_add_u32 m0, s29, 3072
    s_nop 0
    buffer_load_dwordx4 v207, s[12:15], s31 offen lds
    s_add_u32 m0, s30, 0
    s_nop 0
    buffer_load_dwordx4 v208, s[16:19], s32 offen lds
    s_add_u32 m0, s30, 1024
    s_nop 0
    buffer_load_dwordx4 v209, s[16:19], s32 offen lds
    s_add_u32 m0, s30, 2048
    s_nop 0
    buffer_load_dwordx4 v210, s[16:19], s32 offen lds
    s_add_u32 m0, s30, 3072
    s_nop 0
    buffer_load_dwordx4 v211, s[16:19], s32 offen lds
    s_add_u32 s31, s31, 128
    s_add_u32 s32, s32, 524288
    ds_read_b128 v[144:147], v196 offset:0
    ds_read_b128 v[148:151], v196 offset:4096
    ds_read_b128 v[152:155], v196 offset:8192
    ds_read_b128 v[156:159], v196 offset:12288
    ds_read_b64_tr_b16 v[160:161], v202 offset:0
    ds_read_b64_tr_b16 v[162:163], v202 offset:2048
    ds_read_b64_tr_b16 v[164:165], v203 offset:0
    ds_read_b64_tr_b16 v[166:167], v203 offset:2048
    ds_read_b128 v[168:171], v197 offset:0
    ds_read_b128 v[172:175], v197 offset:4096
    ds_read_b128 v[176:179], v197 offset:8192
    ds_read_b128 v[180:183], v197 offset:12288
    ds_read_b64_tr_b16 v[184:185], v202 offset:8192
    ds_read_b64_tr_b16 v[186:187], v202 offset:10240
    ds_read_b64_tr_b16 v[188:189], v203 offset:8192
    ds_read_b64_tr_b16 v[190:191], v203 offset:10240
    s_waitcnt lgkmcnt(8)
    v_mfma_f32_32x32x16_bf16 v[16:31], v[160:163], v[144:147], v[16:31]
    v_mfma_f32_32x32x16_bf16 v[32:47], v[164:167], v[144:147], v[32:47]
    v_mfma_f32_32x32x16_bf16 v[48:63], v[160:163], v[148:151], v[48:63]
    v_mfma_f32_32x32x16_bf16 v[64:79], v[164:167], v[148:151], v[64:79]
    v_mfma_f32_32x32x16_bf16 v[80:95], v[160:163], v[152:155], v[80:95]
    v_mfma_f32_32x32x16_bf16 v[96:111], v[164:167], v[152:155], v[96:111]
    v_mfma_f32_32x32x16_bf16 v[112:127], v[160:163], v[156:159], v[112:127]
    v_mfma_f32_32x32x16_bf16 v[128:143], v[164:167], v[156:159], v[128:143]
    ds_read_b128 v[144:147], v198 offset:0
    ds_read_b128 v[148:151], v198 offset:4096
    ds_read_b128 v[152:155], v198 offset:8192
    ds_read_b128 v[156:159], v198 offset:12288
    ds_read_b64_tr_b16 v[160:161], v202 offset:16384
    ds_read_b64_tr_b16 v[162:163], v202 offset:18432
    ds_read_b64_tr_b16 v[164:165], v203 offset:16384
    ds_read_b64_tr_b16 v[166:167], v203 offset:18432
    s_waitcnt lgkmcnt(8)
    v_mfma_f32_32x32x16_bf16 v[16:31], v[184:187], v[168:171], v[16:31]
    v_mfma_f32_32x32x16_bf16 v[32:47], v[188:191], v[168:171], v[32:47]
    v_mfma_f32_32x32x16_bf16 v[48:63], v[184:187], v[172:175], v[48:63]
    v_mfma_f32_32x32x16_bf16 v[64:79], v[188:191], v[172:175], v[64:79]
    v_mfma_f32_32x32x16_bf16 v[80:95], v[184:187], v[176:179], v[80:95]
    v_mfma_f32_32x32x16_bf16 v[96:111], v[188:191], v[176:179], v[96:111]
    v_mfma_f32_32x32x16_bf16 v[112:127], v[184:187], v[180:183], v[112:127]
    v_mfma_f32_32x32x16_bf16 v[128:143], v[188:191], v[180:183], v[128:143]
    ds_read_b128 v[168:171], v199 offset:0
    ds_read_b128 v[172:175], v199 offset:4096
    ds_read_b128 v[176:179], v199 offset:8192
    ds_read_b128 v[180:183], v199 offset:12288
    ds_read_b64_tr_b16 v[184:185], v202 offset:24576
    ds_read_b64_tr_b16 v[186:187], v202 offset:26624
    ds_read_b64_tr_b16 v[188:189], v203 offset:24576
    ds_read_b64_tr_b16 v[190:191], v203 offset:26624
    s_waitcnt lgkmcnt(8)
    v_mfma_f32_32x32x16_bf16 v[16:31], v[160:163], v[144:147], v[16:31]
    v_mfma_f32_32x32x16_bf16 v[32:47], v[164:167], v[144:147], v[32:47]
    v_mfma_f32_32x32x16_bf16 v[48:63], v[160:163], v[148:151], v[48:63]
    v_mfma_f32_32x32x16_bf16 v[64:79], v[164:167], v[148:151], v[64:79]
    v_mfma_f32_32x32x16_bf16 v[80:95], v[160:163], v[152:155], v[80:95]
    v_mfma_f32_32x32x16_bf16 v[96:111], v[164:167], v[152:155], v[96:111]
    v_mfma_f32_32x32x16_bf16 v[112:127], v[160:163], v[156:159], v[112:127]
    v_mfma_f32_32x32x16_bf16 v[128:143], v[164:167], v[156:159], v[128:143]
    s_waitcnt lgkmcnt(0)
    v_mfma_f32_32x32x16_bf16 v[16:31], v[184:187], v[168:171], v[16:31]
    v_mfma_f32_32x32x16_bf16 v[32:47], v[188:191], v[168:171], v[32:47]
    v_mfma_f32_32x32x16_bf16 v[48:63], v[184:187], v[172:175], v[48:63]
    v_mfma_f32_32x32x16_bf16 v[64:79], v[188:191], v[172:175], v[64:79]
    v_mfma_f32_32x32x16_bf16 v[80:95], v[184:187], v[176:179], v[80:95]
    v_mfma_f32_32x32x16_bf16 v[96:111], v[188:191], v[176:179], v[96:111]
    v_mfma_f32_32x32x16_bf16 v[112:127], v[184:187], v[180:183], v[112:127]
    v_mfma_f32_32x32x16_bf16 v[128:143], v[188:191], v[180:183], v[128:143]
    s_waitcnt vmcnt(0)
    s_barrier
    s_add_u32 m0, s29, 65536
    s_nop 0
    buffer_load_dwordx4 v204, s[12:15], s31 offen lds
    s_add_u32 m0, s29, 66560
    s_nop 0
    buffer_load_dwordx4 v205, s[12:15], s31 offen lds
    s_add_u32 m0, s29, 67584
    s_nop 0
    buffer_load_dwordx4 v206, s[12:15], s31 offen lds
    s_add_u32 m0, s29, 68608
    s_nop 0
    buffer_load_dwordx4 v207, s[12:15], s31 offen lds
    s_add_u32 m0, s30, 65536
    s_nop 0
    buffer_load_dwordx4 v208, s[16:19], s32 offen lds
    s_add_u32 m0, s30, 66560
    s_nop 0
    buffer_load_dwordx4 v209, s[16:19], s32 offen lds
    s_add_u32 m0, s30, 67584
    s_nop 0
    buffer_load_dwordx4 v210, s[16:19], s32 offen lds
    s_add_u32 m0, s30, 68608
    s_nop 0
    buffer_load_dwordx4 v211, s[16:19], s32 offen lds
    s_add_u32 s31, s31, 128
    s_add_u32 s32, s32, 524288
    ds_read_b128 v[144:147], v192 offset:0
    ds_read_b128 v[148:151], v192 offset:4096
    ds_read_b128 v[152:155], v192 offset:8192
    ds_read_b128 v[156:159], v192 offset:12288
    ds_read_b64_tr_b16 v[160:161], v200 offset:0
    ds_read_b64_tr_b16 v[162:163], v200 offset:2048
    ds_read_b64_tr_b16 v[164:165], v201 offset:0
    ds_read_b64_tr_b16 v[166:167], v201 offset:2048
    ds_read_b128 v[168:171], v193 offset:0
    ds_read_b128 v[172:175], v193 offset:4096
    ds_read_b128 v[176:179], v193 offset:8192
    ds_read_b128 v[180:183], v193 offset:12288
    ds_read_b64_tr_b16 v[184:185], v200 offset:8192
    ds_read_b64_tr_b16 v[186:187], v200 offset:10240
    ds_read_b64_tr_b16 v[188:189], v201 offset:8192
    ds_read_b64_tr_b16 v[190:191], v201 offset:10240
    s_waitcnt lgkmcnt(8)
    v_mfma_f32_32x32x16_bf16 v[16:31], v[160:163], v[144:147], v[16:31]
    v_mfma_f32_32x32x16_bf16 v[32:47], v[164:167], v[144:147], v[32:47]
    v_mfma_f32_32x32x16_bf16 v[48:63], v[160:163], v[148:151], v[48:63]
    v_mfma_f32_32x32x16_bf16 v[64:79], v[164:167], v[148:151], v[64:79]
    v_mfma_f32_32x32x16_bf16 v[80:95], v[160:163], v[152:155], v[80:95]
    v_mfma_f32_32x32x16_bf16 v[96:111], v[164:167], v[152:155], v[96:111]
    v_mfma_f32_32x32x16_bf16 v[112:127], v[160:163], v[156:159], v[112:127]
    v_mfma_f32_32x32x16_bf16 v[128:143], v[164:167], v[156:159], v[128:143]
    ds_read_b128 v[144:147], v194 offset:0
    ds_read_b128 v[148:151], v194 offset:4096
    ds_read_b128 v[152:155], v194 offset:8192
    ds_read_b128 v[156:159], v194 offset:12288
    ds_read_b64_tr_b16 v[160:161], v200 offset:16384
    ds_read_b64_tr_b16 v[162:163], v200 offset:18432
    ds_read_b64_tr_b16 v[164:165], v201 offset:16384
    ds_read_b64_tr_b16 v[166:167], v201 offset:18432
    s_waitcnt lgkmcnt(8)
    v_mfma_f32_32x32x16_bf16 v[16:31], v[184:187], v[168:171], v[16:31]
    v_mfma_f32_32x32x16_bf16 v[32:47], v[188:191], v[168:171], v[32:47]
    v_mfma_f32_32x32x16_bf16 v[48:63], v[184:187], v[172:175], v[48:63]
    v_mfma_f32_32x32x16_bf16 v[64:79], v[188:191], v[172:175], v[64:79]
    v_mfma_f32_32x32x16_bf16 v[80:95], v[184:187], v[176:179], v[80:95]
    v_mfma_f32_32x32x16_bf16 v[96:111], v[188:191], v[176:179], v[96:111]
    v_mfma_f32_32x32x16_bf16 v[112:127], v[184:187], v[180:183], v[112:127]
    v_mfma_f32_32x32x16_bf16 v[128:143], v[188:191], v[180:183], v[128:143]
    ds_read_b128 v[168:171], v195 offset:0
    ds_read_b128 v[172:175], v195 offset:4096
    ds_read_b128 v[176:179], v195 offset:8192
    ds_read_b128 v[180:183], v195 offset:12288
    ds_read_b64_tr_b16 v[184:185], v200 offset:24576
    ds_read_b64_tr_b16 v[186:187], v200 offset:26624
    ds_read_b64_tr_b16 v[188:189], v201 offset:24576
    ds_read_b64_tr_b16 v[190:191], v201 offset:26624
    s_waitcnt lgkmcnt(8)
    v_mfma_f32_32x32x16_bf16 v[16:31], v[160:163], v[144:147], v[16:31]
    v_mfma_f32_32x32x16_bf16 v[32:47], v[164:167], v[144:147], v[32:47]
    v_mfma_f32_32x32x16_bf16 v[48:63], v[160:163], v[148:151], v[48:63]
    v_mfma_f32_32x32x16_bf16 v[64:79], v[164:167], v[148:151], v[64:79]
    v_mfma_f32_32x32x16_bf16 v[80:95], v[160:163], v[152:155], v[80:95]
    v_mfma_f32_32x32x16_bf16 v[96:111], v[164:167], v[152:155], v[96:111]
    v_mfma_f32_32x32x16_bf16 v[112:127], v[160:163], v[156:159], v[112:127]
    v_mfma_f32_32x32x16_bf16 v[128:143], v[164:167], v[156:159], v[128:143]
    s_waitcnt lgkmcnt(0)
    v_mfma_f32_32x32x16_bf16 v[16:31], v[184:187], v[168:171], v[16:31]
    v_mfma_f32_32x32x16_bf16 v[32:47], v[188:191], v[168:171], v[32:47]
    v_mfma_f32_32x32x16_bf16 v[48:63], v[184:187], v[172:175], v[48:63]
    v_mfma_f32_32x32x16_bf16 v[64:79], v[188:191], v[172:175], v[64:79]
    v_mfma_f32_32x32x16_bf16 v[80:95], v[184:187], v[176:179], v[80:95]
    v_mfma_f32_32x32x16_bf16 v[96:111], v[188:191], v[176:179], v[96:111]
    v_mfma_f32_32x32x16_bf16 v[112:127], v[184:187], v[180:183], v[112:127]
    v_mfma_f32_32x32x16_bf16 v[128:143], v[188:191], v[180:183], v[128:143]
    s_waitcnt vmcnt(0)
    s_barrier
    s_add_u32 m0, s29, 0
    s_nop 0
    buffer_load_dwordx4 v204, s[12:15], s31 offen lds
    s_add_u32 m0, s29, 1024
    s_nop 0
    buffer_load_dwordx4 v205, s[12:15], s31 offen lds
    s_add_u32 m0, s29, 2048
    s_nop 0
    buffer_load_dwordx4 v206, s[12:15], s31 offen lds
    s_add_u32 m0, s29, 3072
    s_nop 0
    buffer_load_dwordx4 v207, s[12:15], s31 offen lds
    s_add_u32 m0, s30, 0
    s_nop 0
    buffer_load_dwordx4 v208, s[16:19], s32 offen lds
    s_add_u32 m0, s30, 1024
    s_nop 0
    buffer_load_dwordx4 v209, s[16:19], s32 offen lds
    s_add_u32 m0, s30, 2048
    s_nop 0
    buffer_load_dwordx4 v210, s[16:19], s32 offen lds
    s_add_u32 m0, s30, 3072
    s_nop 0
    buffer_load_dwordx4 v211, s[16:19], s32 offen lds
    s_add_u32 s31, s31, 128
    s_add_u32 s32, s32, 524288
    ds_read_b128 v[144:147], v196 offset:0
    ds_read_b128 v[148:151], v196 offset:4096
    ds_read_b128 v[152:155], v196 offset:8192
    ds_read_b128 v[156:159], v196 offset:12288
    ds_read_b64_tr_b16 v[160:161], v202 offset:0
    ds_read_b64_tr_b16 v[162:163], v202 offset:2048
    ds_read_b64_tr_b16 v[164:165], v203 offset:0
    ds_read_b64_tr_b16 v[166:167], v203 offset:2048
    ds_read_b128 v[168:171], v197 offset:0
    ds_read_b128 v[172:175], v197 offset:4096
    ds_read_b128 v[176:179], v197 offset:8192
    ds_read_b128 v[180:183], v197 offset:12288
    ds_read_b64_tr_b16 v[184:185], v202 offset:8192
    ds_read_b64_tr_b16 v[186:187], v202 offset:10240
    ds_read_b64_tr_b16 v[188:189], v203 offset:8192
    ds_read_b64_tr_b16 v[190:191], v203 offset:10240
    s_waitcnt lgkmcnt(8)
    v_mfma_f32_32x32x16_bf16 v[16:31], v[160:163], v[144:147], v[16:31]
    v_mfma_f32_32x32x16_bf16 v[32:47], v[164:167], v[144:147], v[32:47]
    v_mfma_f32_32x32x16_bf16 v[48:63], v[160:163], v[148:151], v[48:63]
    v_mfma_f32_32x32x16_bf16 v[64:79], v[164:167], v[148:151], v[64:79]
    v_mfma_f32_32x32x16_bf16 v[80:95], v[160:163], v[152:155], v[80:95]
    v_mfma_f32_32x32x16_bf16 v[96:111], v[164:167], v[152:155], v[96:111]
    v_mfma_f32_32x32x16_bf16 v[112:127], v[160:163], v[156:159], v[112:127]
    v_mfma_f32_32x32x16_bf16 v[128:143], v[164:167], v[156:159], v[128:143]
    ds_read_b128 v[144:147], v198 offset:0
    ds_read_b128 v[148:151], v198 offset:4096
    ds_read_b128 v[152:155], v198 offset:8192
    ds_read_b128 v[156:159], v198 offset:12288
    ds_read_b64_tr_b16 v[160:161], v202 offset:16384
    ds_read_b64_tr_b16 v[162:163], v202 offset:18432
    ds_read_b64_tr_b16 v[164:165], v203 offset:16384
    ds_read_b64_tr_b16 v[166:167], v203 offset:18432
    s_waitcnt lgkmcnt(8)
    v_mfma_f32_32x32x16_bf16 v[16:31], v[184:187], v[168:171], v[16:31]
    v_mfma_f32_32x32x16_bf16 v[32:47], v[188:191], v[168:171], v[32:47]
    v_mfma_f32_32x32x16_bf16 v[48:63], v[184:187], v[172:175], v[48:63]
    v_mfma_f32_32x32x16_bf16 v[64:79], v[188:191], v[172:175], v[64:79]
    v_mfma_f32_32x32x16_bf16 v[80:95], v[184:187], v[176:179], v[80:95]
    v_mfma_f32_32x32x16_bf16 v[96:111], v[188:191], v[176:179], v[96:111]
    v_mfma_f32_32x32x16_bf16 v[112:127], v[184:187], v[180:183], v[112:127]
    v_mfma_f32_32x32x16_bf16 v[128:143], v[188:191], v[180:183], v[128:143]
    ds_read_b128 v[168:171], v199 offset:0
    ds_read_b128 v[172:175], v199 offset:4096
    ds_read_b128 v[176:179], v199 offset:8192
    ds_read_b128 v[180:183], v199 offset:12288
    ds_read_b64_tr_b16 v[184:185], v202 offset:24576
    ds_read_b64_tr_b16 v[186:187], v202 offset:26624
    ds_read_b64_tr_b16 v[188:189], v203 offset:24576
    ds_read_b64_tr_b16 v[190:191], v203 offset:26624
    s_waitcnt lgkmcnt(8)
    v_mfma_f32_32x32x16_bf16 v[16:31], v[160:163], v[144:147], v[16:31]
    v_mfma_f32_32x32x16_bf16 v[32:47], v[164:167], v[144:147], v[32:47]
    v_mfma_f32_32x32x16_bf16 v[48:63], v[160:163], v[148:151], v[48:63]
    v_mfma_f32_32x32x16_bf16 v[64:79], v[164:167], v[148:151], v[64:79]
    v_mfma_f32_32x32x16_bf16 v[80:95], v[160:163], v[152:155], v[80:95]
    v_mfma_f32_32x32x16_bf16 v[96:111], v[164:167], v[152:155], v[96:111]
    v_mfma_f32_32x32x16_bf16 v[112:127], v[160:163], v[156:159], v[112:127]
    v_mfma_f32_32x32x16_bf16 v[128:143], v[164:167], v[156:159], v[128:143]
    s_waitcnt lgkmcnt(0)
    v_mfma_f32_32x32x16_bf16 v[16:31], v[184:187], v[168:171], v[16:31]
    v_mfma_f32_32x32x16_bf16 v[32:47], v[188:191], v[168:171], v[32:47]
    v_mfma_f32_32x32x16_bf16 v[48:63], v[184:187], v[172:175], v[48:63]
    v_mfma_f32_32x32x16_bf16 v[64:79], v[188:191], v[172:175], v[64:79]
    v_mfma_f32_32x32x16_bf16 v[80:95], v[184:187], v[176:179], v[80:95]
    v_mfma_f32_32x32x16_bf16 v[96:111], v[188:191], v[176:179], v[96:111]
    v_mfma_f32_32x32x16_bf16 v[112:127], v[184:187], v[180:183], v[112:127]
    v_mfma_f32_32x32x16_bf16 v[128:143], v[188:191], v[180:183], v[128:143]
    s_waitcnt vmcnt(0)
    s_barrier
    s_add_u32 m0, s29, 65536
    s_nop 0
    buffer_load_dwordx4 v204, s[12:15], s31 offen lds
    s_add_u32 m0, s29, 66560
    s_nop 0
    buffer_load_dwordx4 v205, s[12:15], s31 offen lds
    s_add_u32 m0, s29, 67584
    s_nop 0
    buffer_load_dwordx4 v206, s[12:15], s31 offen lds
    s_add_u32 m0, s29, 68608
    s_nop 0
    buffer_load_dwordx4 v207, s[12:15], s31 offen lds
    s_add_u32 m0, s30, 65536
    s_nop 0
    buffer_load_dwordx4 v208, s[16:19], s32 offen lds
    s_add_u32 m0, s30, 66560
    s_nop 0
    buffer_load_dwordx4 v209, s[16:19], s32 offen lds
    s_add_u32 m0, s30, 67584
    s_nop 0
    buffer_load_dwordx4 v210, s[16:19], s32 offen lds
    s_add_u32 m0, s30, 68608
    s_nop 0
    buffer_load_dwordx4 v211, s[16:19], s32 offen lds
    s_add_u32 s31, s31, 128
    s_add_u32 s32, s32, 524288
    ds_read_b128 v[144:147], v192 offset:0
    ds_read_b128 v[148:151], v192 offset:4096
    ds_read_b128 v[152:155], v192 offset:8192
    ds_read_b128 v[156:159], v192 offset:12288
    ds_read_b64_tr_b16 v[160:161], v200 offset:0
    ds_read_b64_tr_b16 v[162:163], v200 offset:2048
    ds_read_b64_tr_b16 v[164:165], v201 offset:0
    ds_read_b64_tr_b16 v[166:167], v201 offset:2048
    ds_read_b128 v[168:171], v193 offset:0
    ds_read_b128 v[172:175], v193 offset:4096
    ds_read_b128 v[176:179], v193 offset:8192
    ds_read_b128 v[180:183], v193 offset:12288
    ds_read_b64_tr_b16 v[184:185], v200 offset:8192
    ds_read_b64_tr_b16 v[186:187], v200 offset:10240
    ds_read_b64_tr_b16 v[188:189], v201 offset:8192
    ds_read_b64_tr_b16 v[190:191], v201 offset:10240
    s_waitcnt lgkmcnt(8)
    v_mfma_f32_32x32x16_bf16 v[16:31], v[160:163], v[144:147], v[16:31]
    v_mfma_f32_32x32x16_bf16 v[32:47], v[164:167], v[144:147], v[32:47]
    v_mfma_f32_32x32x16_bf16 v[48:63], v[160:163], v[148:151], v[48:63]
    v_mfma_f32_32x32x16_bf16 v[64:79], v[164:167], v[148:151], v[64:79]
    v_mfma_f32_32x32x16_bf16 v[80:95], v[160:163], v[152:155], v[80:95]
    v_mfma_f32_32x32x16_bf16 v[96:111], v[164:167], v[152:155], v[96:111]
    v_mfma_f32_32x32x16_bf16 v[112:127], v[160:163], v[156:159], v[112:127]
    v_mfma_f32_32x32x16_bf16 v[128:143], v[164:167], v[156:159], v[128:143]
    ds_read_b128 v[144:147], v194 offset:0
    ds_read_b128 v[148:151], v194 offset:4096
    ds_read_b128 v[152:155], v194 offset:8192
    ds_read_b128 v[156:159], v194 offset:12288
    ds_read_b64_tr_b16 v[160:161], v200 offset:16384
    ds_read_b64_tr_b16 v[162:163], v200 offset:18432
    ds_read_b64_tr_b16 v[164:165], v201 offset:16384
    ds_read_b64_tr_b16 v[166:167], v201 offset:18432
    s_waitcnt lgkmcnt(8)
    v_mfma_f32_32x32x16_bf16 v[16:31], v[184:187], v[168:171], v[16:31]
    v_mfma_f32_32x32x16_bf16 v[32:47], v[188:191], v[168:171], v[32:47]
    v_mfma_f32_32x32x16_bf16 v[48:63], v[184:187], v[172:175], v[48:63]
    v_mfma_f32_32x32x16_bf16 v[64:79], v[188:191], v[172:175], v[64:79]
    v_mfma_f32_32x32x16_bf16 v[80:95], v[184:187], v[176:179], v[80:95]
    v_mfma_f32_32x32x16_bf16 v[96:111], v[188:191], v[176:179], v[96:111]
    v_mfma_f32_32x32x16_bf16 v[112:127], v[184:187], v[180:183], v[112:127]
    v_mfma_f32_32x32x16_bf16 v[128:143], v[188:191], v[180:183], v[128:143]
    ds_read_b128 v[168:171], v195 offset:0
    ds_read_b128 v[172:175], v195 offset:4096
    ds_read_b128 v[176:179], v195 offset:8192
    ds_read_b128 v[180:183], v195 offset:12288
    ds_read_b64_tr_b16 v[184:185], v200 offset:24576
    ds_read_b64_tr_b16 v[186:187], v200 offset:26624
    ds_read_b64_tr_b16 v[188:189], v201 offset:24576
    ds_read_b64_tr_b16 v[190:191], v201 offset:26624
    s_waitcnt lgkmcnt(8)
    v_mfma_f32_32x32x16_bf16 v[16:31], v[160:163], v[144:147], v[16:31]
    v_mfma_f32_32x32x16_bf16 v[32:47], v[164:167], v[144:147], v[32:47]
    v_mfma_f32_32x32x16_bf16 v[48:63], v[160:163], v[148:151], v[48:63]
    v_mfma_f32_32x32x16_bf16 v[64:79], v[164:167], v[148:151], v[64:79]
    v_mfma_f32_32x32x16_bf16 v[80:95], v[160:163], v[152:155], v[80:95]
    v_mfma_f32_32x32x16_bf16 v[96:111], v[164:167], v[152:155], v[96:111]
    v_mfma_f32_32x32x16_bf16 v[112:127], v[160:163], v[156:159], v[112:127]
    v_mfma_f32_32x32x16_bf16 v[128:143], v[164:167], v[156:159], v[128:143]
    s_waitcnt lgkmcnt(0)
    v_mfma_f32_32x32x16_bf16 v[16:31], v[184:187], v[168:171], v[16:31]
    v_mfma_f32_32x32x16_bf16 v[32:47], v[188:191], v[168:171], v[32:47]
    v_mfma_f32_32x32x16_bf16 v[48:63], v[184:187], v[172:175], v[48:63]
    v_mfma_f32_32x32x16_bf16 v[64:79], v[188:191], v[172:175], v[64:79]
    v_mfma_f32_32x32x16_bf16 v[80:95], v[184:187], v[176:179], v[80:95]
    v_mfma_f32_32x32x16_bf16 v[96:111], v[188:191], v[176:179], v[96:111]
    v_mfma_f32_32x32x16_bf16 v[112:127], v[184:187], v[180:183], v[112:127]
    v_mfma_f32_32x32x16_bf16 v[128:143], v[188:191], v[180:183], v[128:143]
    s_waitcnt vmcnt(0)
    s_barrier
    ds_read_b128 v[144:147], v196 offset:0
    ds_read_b128 v[148:151], v196 offset:4096
    ds_read_b128 v[152:155], v196 offset:8192
    ds_read_b128 v[156:159], v196 offset:12288
    ds_read_b64_tr_b16 v[160:161], v202 offset:0
    ds_read_b64_tr_b16 v[162:163], v202 offset:2048
    ds_read_b64_tr_b16 v[164:165], v203 offset:0
    ds_read_b64_tr_b16 v[166:167], v203 offset:2048
    ds_read_b128 v[168:171], v197 offset:0
    ds_read_b128 v[172:175], v197 offset:4096
    ds_read_b128 v[176:179], v197 offset:8192
    ds_read_b128 v[180:183], v197 offset:12288
    ds_read_b64_tr_b16 v[184:185], v202 offset:8192
    ds_read_b64_tr_b16 v[186:187], v202 offset:10240
    ds_read_b64_tr_b16 v[188:189], v203 offset:8192
    ds_read_b64_tr_b16 v[190:191], v203 offset:10240
    s_waitcnt lgkmcnt(8)
    v_mfma_f32_32x32x16_bf16 v[16:31], v[160:163], v[144:147], v[16:31]
    v_mfma_f32_32x32x16_bf16 v[32:47], v[164:167], v[144:147], v[32:47]
    v_mfma_f32_32x32x16_bf16 v[48:63], v[160:163], v[148:151], v[48:63]
    v_mfma_f32_32x32x16_bf16 v[64:79], v[164:167], v[148:151], v[64:79]
    v_mfma_f32_32x32x16_bf16 v[80:95], v[160:163], v[152:155], v[80:95]
    v_mfma_f32_32x32x16_bf16 v[96:111], v[164:167], v[152:155], v[96:111]
    v_mfma_f32_32x32x16_bf16 v[112:127], v[160:163], v[156:159], v[112:127]
    v_mfma_f32_32x32x16_bf16 v[128:143], v[164:167], v[156:159], v[128:143]
    ds_read_b128 v[144:147], v198 offset:0
    ds_read_b128 v[148:151], v198 offset:4096
    ds_read_b128 v[152:155], v198 offset:8192
    ds_read_b128 v[156:159], v198 offset:12288
    ds_read_b64_tr_b16 v[160:161], v202 offset:16384
    ds_read_b64_tr_b16 v[162:163], v202 offset:18432
    ds_read_b64_tr_b16 v[164:165], v203 offset:16384
    ds_read_b64_tr_b16 v[166:167], v203 offset:18432
    s_waitcnt lgkmcnt(8)
    v_mfma_f32_32x32x16_bf16 v[16:31], v[184:187], v[168:171], v[16:31]
    v_mfma_f32_32x32x16_bf16 v[32:47], v[188:191], v[168:171], v[32:47]
    v_mfma_f32_32x32x16_bf16 v[48:63], v[184:187], v[172:175], v[48:63]
    v_mfma_f32_32x32x16_bf16 v[64:79], v[188:191], v[172:175], v[64:79]
    v_mfma_f32_32x32x16_bf16 v[80:95], v[184:187], v[176:179], v[80:95]
    v_mfma_f32_32x32x16_bf16 v[96:111], v[188:191], v[176:179], v[96:111]
    v_mfma_f32_32x32x16_bf16 v[112:127], v[184:187], v[180:183], v[112:127]
    v_mfma_f32_32x32x16_bf16 v[128:143], v[188:191], v[180:183], v[128:143]
    ds_read_b128 v[168:171], v199 offset:0
    ds_read_b128 v[172:175], v199 offset:4096
    ds_read_b128 v[176:179], v199 offset:8192
    ds_read_b128 v[180:183], v199 offset:12288
    ds_read_b64_tr_b16 v[184:185], v202 offset:24576
    ds_read_b64_tr_b16 v[186:187], v202 offset:26624
    ds_read_b64_tr_b16 v[188:189], v203 offset:24576
    ds_read_b64_tr_b16 v[190:191], v203 offset:26624
    s_waitcnt lgkmcnt(8)
    v_mfma_f32_32x32x16_bf16 v[16:31], v[160:163], v[144:147], v[16:31]
    v_mfma_f32_32x32x16_bf16 v[32:47], v[164:167], v[144:147], v[32:47]
    v_mfma_f32_32x32x16_bf16 v[48:63], v[160:163], v[148:151], v[48:63]
    v_mfma_f32_32x32x16_bf16 v[64:79], v[164:167], v[148:151], v[64:79]
    v_mfma_f32_32x32x16_bf16 v[80:95], v[160:163], v[152:155], v[80:95]
    v_mfma_f32_32x32x16_bf16 v[96:111], v[164:167], v[152:155], v[96:111]
    v_mfma_f32_32x32x16_bf16 v[112:127], v[160:163], v[156:159], v[112:127]
    v_mfma_f32_32x32x16_bf16 v[128:143], v[164:167], v[156:159], v[128:143]
    s_waitcnt lgkmcnt(0)
    v_mfma_f32_32x32x16_bf16 v[16:31], v[184:187], v[168:171], v[16:31]
    v_mfma_f32_32x32x16_bf16 v[32:47], v[188:191], v[168:171], v[32:47]
    v_mfma_f32_32x32x16_bf16 v[48:63], v[184:187], v[172:175], v[48:63]
    v_mfma_f32_32x32x16_bf16 v[64:79], v[188:191], v[172:175], v[64:79]
    v_mfma_f32_32x32x16_bf16 v[80:95], v[184:187], v[176:179], v[80:95]
    v_mfma_f32_32x32x16_bf16 v[96:111], v[188:191], v[176:179], v[96:111]
    v_mfma_f32_32x32x16_bf16 v[112:127], v[184:187], v[180:183], v[112:127]
    v_mfma_f32_32x32x16_bf16 v[128:143], v[188:191], v[180:183], v[128:143]
    v_lshlrev_b32 v216, 4, v1
    s_lshr_b32 s27, s26, 1
    s_lshl_b32 s27, s27, 6
    s_lshl_b32 s28, s25, 5
    s_add_u32 s27, s27, s28
    s_and_b32 s28, s26, 1
    s_lshl_b32 s28, s28, 2
    s_add_u32 s27, s27, s28
    s_lshl_b32 s27, s27, 10
    v_cvt_pk_bf16_f32 v16, v16, v17
    v_cvt_pk_bf16_f32 v17, v18, v19
    v_cvt_pk_bf16_f32 v18, v20, v21
    v_cvt_pk_bf16_f32 v19, v22, v23
    s_nop 0
    v_permlane32_swap_b32 v16, v18
    v_permlane32_swap_b32 v17, v19
    s_add_u32 s28, s27, 0
    buffer_store_dwordx4 v[16:19], v216, s[20:23], s28 offen
    v_cvt_pk_bf16_f32 v24, v24, v25
    v_cvt_pk_bf16_f32 v25, v26, v27
    v_cvt_pk_bf16_f32 v26, v28, v29
    v_cvt_pk_bf16_f32 v27, v30, v31
    s_nop 0
    v_permlane32_swap_b32 v24, v26
    v_permlane32_swap_b32 v25, v27
    s_add_u32 s28, s27, 1024
    buffer_store_dwordx4 v[24:27], v216, s[20:23], s28 offen
    v_cvt_pk_bf16_f32 v32, v32, v33
    v_cvt_pk_bf16_f32 v33, v34, v35
    v_cvt_pk_bf16_f32 v34, v36, v37
    v_cvt_pk_bf16_f32 v35, v38, v39
    s_nop 0
    v_permlane32_swap_b32 v32, v34
    v_permlane32_swap_b32 v33, v35
    s_add_u32 s28, s27, 2048
    buffer_store_dwordx4 v[32:35], v216, s[20:23], s28 offen
    v_cvt_pk_bf16_f32 v40, v40, v41
    v_cvt_pk_bf16_f32 v41, v42, v43
    v_cvt_pk_bf16_f32 v42, v44, v45
    v_cvt_pk_bf16_f32 v43, v46, v47
    s_nop 0
    v_permlane32_swap_b32 v40, v42
    v_permlane32_swap_b32 v41, v43
    s_add_u32 s28, s27, 3072
    buffer_store_dwordx4 v[40:43], v216, s[20:23], s28 offen
    v_cvt_pk_bf16_f32 v48, v48, v49
    v_cvt_pk_bf16_f32 v49, v50, v51
    v_cvt_pk_bf16_f32 v50, v52, v53
    v_cvt_pk_bf16_f32 v51, v54, v55
    s_nop 0
    v_permlane32_swap_b32 v48, v50
    v_permlane32_swap_b32 v49, v51
    s_add_u32 s28, s27, 8192
    buffer_store_dwordx4 v[48:51], v216, s[20:23], s28 offen
    v_cvt_pk_bf16_f32 v56, v56, v57
    v_cvt_pk_bf16_f32 v57, v58, v59
    v_cvt_pk_bf16_f32 v58, v60, v61
    v_cvt_pk_bf16_f32 v59, v62, v63
    s_nop 0
    v_permlane32_swap_b32 v56, v58
    v_permlane32_swap_b32 v57, v59
    s_add_u32 s28, s27, 9216
    buffer_store_dwordx4 v[56:59], v216, s[20:23], s28 offen
    v_cvt_pk_bf16_f32 v64, v64, v65
    v_cvt_pk_bf16_f32 v65, v66, v67
    v_cvt_pk_bf16_f32 v66, v68, v69
    v_cvt_pk_bf16_f32 v67, v70, v71
    s_nop 0
    v_permlane32_swap_b32 v64, v66
    v_permlane32_swap_b32 v65, v67
    s_add_u32 s28, s27, 10240
    buffer_store_dwordx4 v[64:67], v216, s[20:23], s28 offen
    v_cvt_pk_bf16_f32 v72, v72, v73
    v_cvt_pk_bf16_f32 v73, v74, v75
    v_cvt_pk_bf16_f32 v74, v76, v77
    v_cvt_pk_bf16_f32 v75, v78, v79
    s_nop 0
    v_permlane32_swap_b32 v72, v74
    v_permlane32_swap_b32 v73, v75
    s_add_u32 s28, s27, 11264
    buffer_store_dwordx4 v[72:75], v216, s[20:23], s28 offen
    v_cvt_pk_bf16_f32 v80, v80, v81
    v_cvt_pk_bf16_f32 v81, v82, v83
    v_cvt_pk_bf16_f32 v82, v84, v85
    v_cvt_pk_bf16_f32 v83, v86, v87
    s_nop 0
    v_permlane32_swap_b32 v80, v82
    v_permlane32_swap_b32 v81, v83
    s_add_u32 s28, s27, 16384
    buffer_store_dwordx4 v[80:83], v216, s[20:23], s28 offen
    v_cvt_pk_bf16_f32 v88, v88, v89
    v_cvt_pk_bf16_f32 v89, v90, v91
    v_cvt_pk_bf16_f32 v90, v92, v93
    v_cvt_pk_bf16_f32 v91, v94, v95
    s_nop 0
    v_permlane32_swap_b32 v88, v90
    v_permlane32_swap_b32 v89, v91
    s_add_u32 s28, s27, 17408
    buffer_store_dwordx4 v[88:91], v216, s[20:23], s28 offen
    v_cvt_pk_bf16_f32 v96, v96, v97
    v_cvt_pk_bf16_f32 v97, v98, v99
    v_cvt_pk_bf16_f32 v98, v100, v101
    v_cvt_pk_bf16_f32 v99, v102, v103
    s_nop 0
    v_permlane32_swap_b32 v96, v98
    v_permlane32_swap_b32 v97, v99
    s_add_u32 s28, s27, 18432
    buffer_store_dwordx4 v[96:99], v216, s[20:23], s28 offen
    v_cvt_pk_bf16_f32 v104, v104, v105
    v_cvt_pk_bf16_f32 v105, v106, v107
    v_cvt_pk_bf16_f32 v106, v108, v109
    v_cvt_pk_bf16_f32 v107, v110, v111
    s_nop 0
    v_permlane32_swap_b32 v104, v106
    v_permlane32_swap_b32 v105, v107
    s_add_u32 s28, s27, 19456
    buffer_store_dwordx4 v[104:107], v216, s[20:23], s28 offen
    v_cvt_pk_bf16_f32 v112, v112, v113
    v_cvt_pk_bf16_f32 v113, v114, v115
    v_cvt_pk_bf16_f32 v114, v116, v117
    v_cvt_pk_bf16_f32 v115, v118, v119
    s_nop 0
    v_permlane32_swap_b32 v112, v114
    v_permlane32_swap_b32 v113, v115
    s_add_u32 s28, s27, 24576
    buffer_store_dwordx4 v[112:115], v216, s[20:23], s28 offen
    v_cvt_pk_bf16_f32 v120, v120, v121
    v_cvt_pk_bf16_f32 v121, v122, v123
    v_cvt_pk_bf16_f32 v122, v124, v125
    v_cvt_pk_bf16_f32 v123, v126, v127
    s_nop 0
    v_permlane32_swap_b32 v120, v122
    v_permlane32_swap_b32 v121, v123
    s_add_u32 s28, s27, 25600
    buffer_store_dwordx4 v[120:123], v216, s[20:23], s28 offen
    v_cvt_pk_bf16_f32 v128, v128, v129
    v_cvt_pk_bf16_f32 v129, v130, v131
    v_cvt_pk_bf16_f32 v130, v132, v133
    v_cvt_pk_bf16_f32 v131, v134, v135
    s_nop 0
    v_permlane32_swap_b32 v128, v130
    v_permlane32_swap_b32 v129, v131
    s_add_u32 s28, s27, 26624
    buffer_store_dwordx4 v[128:131], v216, s[20:23], s28 offen
    v_cvt_pk_bf16_f32 v136, v136, v137
    v_cvt_pk_bf16_f32 v137, v138, v139
    v_cvt_pk_bf16_f32 v138, v140, v141
    v_cvt_pk_bf16_f32 v139, v142, v143
    s_nop 0
    v_permlane32_swap_b32 v136, v138
    v_permlane32_swap_b32 v137, v139
    s_add_u32 s28, s27, 27648
    buffer_store_dwordx4 v[136:139], v216, s[20:23], s28 offen
    s_waitcnt vmcnt(0)
gemm1_kernel_exit:
    s_endpgm
.globl attn_kernel
.p2align 8
.type attn_kernel,@function
attn_kernel:
    s_cmp_ge_u32 s2, 256
    s_cbranch_scc1 attn_kernel_exit
    s_lshr_b32 s34, s2, 5
    s_and_b32 s35, s2, 31
    s_load_dwordx2 s[4:5], s[0:1], 8
    s_load_dwordx2 s[6:7], s[0:1], 16
    s_load_dwordx2 s[36:37], s[0:1], 48
    s_load_dwordx2 s[38:39], s[0:1], 56
    s_load_dwordx2 s[8:9], s[0:1], 96
    s_waitcnt lgkmcnt(0)
    s_lshl_b32 s40, s34, 5
    s_add_u32 s40, s40, s35
    s_lshl_b32 s40, s40, 18
    s_add_u32 s12, s4, s40
    s_addc_u32 s13, s5, 0
    s_mov_b32 s14, 262144
    s_mov_b32 s15, 0x00020000
    s_add_u32 s16, s6, s40
    s_addc_u32 s17, s7, 0
    s_mov_b32 s18, 262144
    s_mov_b32 s19, 0x00020000
    s_add_u32 s44, s36, s40
    s_addc_u32 s45, s37, 0
    s_mov_b32 s46, 262144
    s_mov_b32 s47, 0x00020000
    s_add_u32 s48, s38, s40
    s_addc_u32 s49, s39, 0
    s_mov_b32 s50, 262144
    s_mov_b32 s51, 0x00020000
    s_lshl_b32 s40, s34, 21
    s_lshl_b32 s41, s35, 16
    s_add_u32 s40, s40, s41
    s_add_u32 s20, s8, s40
    s_addc_u32 s21, s9, 0
    s_mov_b32 s22, 65536
    s_mov_b32 s23, 0x00020000
    s_add_u32 s41, s40, 33554432
    s_add_u32 s24, s8, s41
    s_addc_u32 s25, s9, 0
    s_mov_b32 s26, 65536
    s_mov_b32 s27, 0x00020000
    s_add_u32 s40, s40, 16777216
    s_add_u32 s52, s8, s40
    s_addc_u32 s53, s9, 0
    s_mov_b32 s54, 65536
    s_mov_b32 s55, 0x00020000
    s_add_u32 s41, s40, 33554432
    s_add_u32 s56, s8, s41
    s_addc_u32 s57, s9, 0
    s_mov_b32 s58, 65536
    s_mov_b32 s59, 0x00020000
    v_and_b32 v1, 63, v0
    v_lshrrev_b32 v2, 6, v0
    s_nop 0
    v_readfirstlane_b32 s28, v2
    s_lshl_b32 s29, s28, 5
    v_and_b32 v220, 31, v1
    v_add_u32 v220, s29, v220
    v_cmp_gt_u32 vcc, 240, v220
    v_lshlrev_b32 v221, 13, v220
    v_mov_b32 v222, 0x80000000
    v_cndmask_b32 v227, v222, v221, vcc
    v_min_u32 v220, 239, v220
    v_lshlrev_b32 v220, 13, v220
    v_lshrrev_b32 v221, 5, v1
    v_lshlrev_b32 v221, 4, v221
    v_lshlrev_b32 v220, 4, v1
    s_lshl_b32 s29, s28, 13
    v_add_u32 v3, s29, v220
    v_add_u32 v4, 0x1000, v3
    v_lshrrev_b32 v220, 4, v1
    s_lshl_b32 s29, s28, 3
    v_add_u32 v221, s29, v220
    v_add_u32 v222, 0, v221
    v_xor_b32 v222, v222, v1
    v_and_b32 v222, 15, v222
    v_lshlrev_b32 v222, 4, v222
    v_lshlrev_b32 v223, 8, v221
    v_add_u32 v212, v223, v222
    v_add_u32 v222, 4, v221
    v_xor_b32 v222, v222, v1
    v_and_b32 v222, 15, v222
    v_lshlrev_b32 v222, 4, v222
    v_lshlrev_b32 v223, 8, v221
    v_add_u32 v213, v223, v222
    v_lshrrev_b32 v222, 2, v1
    v_xor_b32 v222, v222, v220
    v_and_b32 v222, 3, v222
    v_lshlrev_b32 v222, 6, v222
    v_and_b32 v223, 3, v1
    v_lshlrev_b32 v223, 4, v223
    v_add_u32 v222, v222, v223
    v_lshlrev_b32 v223, 8, v221
    v_add_u32 v214, v223, v222
    v_and_b32 v220, 31, v1
    v_lshlrev_b32 v220, 8, v220
    v_lshrrev_b32 v221, 5, v1
    v_and_b32 v222, 15, v1
    v_xor_b32 v221, v221, v222
    v_xor_b32 v222, 0, v221
    v_lshlrev_b32 v222, 4, v222
    v_add_u32 v200, v220, v222
    v_xor_b32 v222, 2, v221
    v_lshlrev_b32 v222, 4, v222
    v_add_u32 v201, v220, v222
    v_xor_b32 v222, 4, v221
    v_lshlrev_b32 v222, 4, v222
    v_add_u32 v202, v220, v222
    v_xor_b32 v222, 6, v221
    v_lshlrev_b32 v222, 4, v222
    v_add_u32 v203, v220, v222
    v_xor_b32 v222, 8, v221
    v_lshlrev_b32 v222, 4, v222
    v_add_u32 v204, v220, v222
    v_xor_b32 v222, 10, v221
    v_lshlrev_b32 v222, 4, v222
    v_add_u32 v205, v220, v222
    v_xor_b32 v222, 12, v221
    v_lshlrev_b32 v222, 4, v222
    v_add_u32 v206, v220, v222
    v_xor_b32 v222, 14, v221
    v_lshlrev_b32 v222, 4, v222
    v_add_u32 v207, v220, v222
    v_lshrrev_b32 v220, 2, v1
    v_and_b32 v220, 3, v220
    v_lshrrev_b32 v221, 5, v1
    v_lshlrev_b32 v221, 2, v221
    v_add_u32 v221, v221, v220
    v_lshlrev_b32 v221, 8, v221
    v_add_u32 v221, 0x10000, v221
    v_lshrrev_b32 v222, 4, v1
    v_and_b32 v222, 1, v222
    v_lshlrev_b32 v222, 5, v222
    v_add_u32 v221, v221, v222
    v_and_b32 v222, 3, v1
    v_lshlrev_b32 v222, 3, v222
    v_add_u32 v221, v221, v222
    v_xor_b32 v222, 0, v220
    v_lshlrev_b32 v222, 6, v222
    v_add_u32 v208, v221, v222
    v_xor_b32 v222, 1, v220
    v_lshlrev_b32 v222, 6, v222
    v_add_u32 v209, v221, v222
    v_xor_b32 v222, 2, v220
    v_lshlrev_b32 v222, 6, v222
    v_add_u32 v210, v221, v222
    v_xor_b32 v222, 3, v220
    v_lshlrev_b32 v222, 6, v222
    v_add_u32 v211, v221, v222
    s_mov_b32 s30, 0x3e0293ee
    s_lshl_b32 s29, s28, 11
    s_mov_b32 s31, 0
    s_add_u32 m0, s29, 0
    s_nop 0
    buffer_load_dwordx4 v212, s[12:15], s31 offen lds
    buffer_load_dwordx4 v213, s[12:15], s31 offen offset:1024 lds
    buffer_load_dwordx4 v[8:11], v3, s[20:23], 0 offen offset:0
    buffer_load_dwordx4 v[12:15], v3, s[20:23], 0 offen offset:1024
    buffer_load_dwordx4 v[16:19], v3, s[20:23], 0 offen offset:2048
    buffer_load_dwordx4 v[20:23], v3, s[20:23], 0 offen offset:3072
    buffer_load_dwordx4 v[24:27], v4, s[20:23], 0 offen offset:0
    buffer_load_dwordx4 v[28:31], v4, s[20:23], 0 offen offset:1024
    buffer_load_dwordx4 v[32:35], v4, s[20:23], 0 offen offset:2048
    buffer_load_dwordx4 v[36:39], v4, s[20:23], 0 offen offset:3072
    s_mov_b32 s31, 16384
    s_add_u32 m0, s29, 16384
    s_nop 0
    buffer_load_dwordx4 v212, s[12:15], s31 offen lds
    buffer_load_dwordx4 v213, s[12:15], s31 offen offset:1024 lds
    s_mov_b32 s31, 0
    s_add_u32 m0, s29, 65536
    s_nop 0
    buffer_load_dwordx4 v214, s[16:19], s31 offen lds
    buffer_load_dwordx4 v214, s[16:19], s31 offen offset:1024 lds
    s_mov_b32 s31, 32768
    s_add_u32 m0, s29, 32768
    s_nop 0
    buffer_load_dwordx4 v212, s[12:15], s31 offen lds
    buffer_load_dwordx4 v213, s[12:15], s31 offen offset:1024 lds
    s_mov_b32 s31, 16384
    s_add_u32 m0, s29, 81920
    s_nop 0
    buffer_load_dwordx4 v214, s[16:19], s31 offen lds
    buffer_load_dwordx4 v214, s[16:19], s31 offen offset:1024 lds
    v_mov_b32 v40, 0
    v_mov_b32 v41, 0
    v_mov_b32 v42, 0
    v_mov_b32 v43, 0
    v_mov_b32 v44, 0
    v_mov_b32 v45, 0
    v_mov_b32 v46, 0
    v_mov_b32 v47, 0
    v_mov_b32 v48, 0
    v_mov_b32 v49, 0
    v_mov_b32 v50, 0
    v_mov_b32 v51, 0
    v_mov_b32 v52, 0
    v_mov_b32 v53, 0
    v_mov_b32 v54, 0
    v_mov_b32 v55, 0
    v_mov_b32 v56, 0
    v_mov_b32 v57, 0
    v_mov_b32 v58, 0
    v_mov_b32 v59, 0
    v_mov_b32 v60, 0
    v_mov_b32 v61, 0
    v_mov_b32 v62, 0
    v_mov_b32 v63, 0
    v_mov_b32 v64, 0
    v_mov_b32 v65, 0
    v_mov_b32 v66, 0
    v_mov_b32 v67, 0
    v_mov_b32 v68, 0
    v_mov_b32 v69, 0
    v_mov_b32 v70, 0
    v_mov_b32 v71, 0
    v_mov_b32 v72, 0
    v_mov_b32 v73, 0
    v_mov_b32 v74, 0
    v_mov_b32 v75, 0
    v_mov_b32 v76, 0
    v_mov_b32 v77, 0
    v_mov_b32 v78, 0
    v_mov_b32 v79, 0
    v_mov_b32 v80, 0
    v_mov_b32 v81, 0
    v_mov_b32 v82, 0
    v_mov_b32 v83, 0
    v_mov_b32 v84, 0
    v_mov_b32 v85, 0
    v_mov_b32 v86, 0
    v_mov_b32 v87, 0
    v_mov_b32 v88, 0
    v_mov_b32 v89, 0
    v_mov_b32 v90, 0
    v_mov_b32 v91, 0
    v_mov_b32 v92, 0
    v_mov_b32 v93, 0
    v_mov_b32 v94, 0
    v_mov_b32 v95, 0
    v_mov_b32 v96, 0
    v_mov_b32 v97, 0
    v_mov_b32 v98, 0
    v_mov_b32 v99, 0
    v_mov_b32 v100, 0
    v_mov_b32 v101, 0
    v_mov_b32 v102, 0
    v_mov_b32 v103, 0
    v_mov_b32 v215, 0xf149f2ca
    v_mov_b32 v218, 0xf149f2ca
    v_mov_b32 v217, 0
    v_mov_b32 v216, 0
    v_mov_b32 v224, 0
    v_mov_b32 v225, 0
    v_mov_b32 v226, 0
    s_mov_b32 s60, s12
    s_mov_b32 s64, s16
    s_mov_b32 s61, s13
    s_mov_b32 s65, s17
    s_mov_b32 s62, s14
    s_mov_b32 s66, s18
    s_mov_b32 s63, s15
    s_mov_b32 s67, s19
    s_mov_b32 s68, 0xc000
    s_mov_b32 s69, 0x8000
    s_waitcnt vmcnt(10)
    s_waitcnt vmcnt(8)
    s_barrier
    s_add_u32 m0, s29, 49152
    s_nop 0
    buffer_load_dwordx4 v212, s[60:63], s68 offen lds
    buffer_load_dwordx4 v213, s[60:63], s68 offen offset:1024 lds
    s_add_u32 s68, s68, 16384
    s_add_u32 m0, s29, 98304
    s_nop 0
    buffer_load_dwordx4 v214, s[64:67], s69 offen lds
    buffer_load_dwordx4 v214, s[64:67], s69 offen offset:1024 lds
    s_add_u32 s69, s69, 16384
    ds_read_b128 v[168:171], v200 offset:0
    ds_read_b128 v[172:175], v201 offset:0
    ds_read_b128 v[176:179], v202 offset:0
    ds_read_b128 v[180:183], v203 offset:0
    s_waitcnt lgkmcnt(3)
    v_mfma_f32_32x32x16_bf16 v[104:119], v[168:171], v[8:11], 0
    ds_read_b128 v[168:171], v204 offset:0
    s_waitcnt lgkmcnt(3)
    v_mfma_f32_32x32x16_bf16 v[104:119], v[172:175], v[12:15], v[104:119]
    ds_read_b128 v[172:175], v205 offset:0
    s_waitcnt lgkmcnt(3)
    v_mfma_f32_32x32x16_bf16 v[104:119], v[176:179], v[16:19], v[104:119]
    ds_read_b128 v[176:179], v206 offset:0
    s_waitcnt lgkmcnt(3)
    v_mfma_f32_32x32x16_bf16 v[104:119], v[180:183], v[20:23], v[104:119]
    ds_read_b128 v[180:183], v207 offset:0
    s_waitcnt lgkmcnt(3)
    v_mfma_f32_32x32x16_bf16 v[104:119], v[168:171], v[24:27], v[104:119]
    ds_read_b128 v[168:171], v200 offset:8192
    s_waitcnt lgkmcnt(3)
    v_mfma_f32_32x32x16_bf16 v[104:119], v[172:175], v[28:31], v[104:119]
    ds_read_b128 v[172:175], v201 offset:8192
    s_waitcnt lgkmcnt(3)
    v_mfma_f32_32x32x16_bf16 v[104:119], v[176:179], v[32:35], v[104:119]
    ds_read_b128 v[176:179], v202 offset:8192
    s_waitcnt lgkmcnt(3)
    v_mfma_f32_32x32x16_bf16 v[104:119], v[180:183], v[36:39], v[104:119]
    ds_read_b128 v[180:183], v203 offset:8192
    s_waitcnt lgkmcnt(3)
    v_mfma_f32_32x32x16_bf16 v[120:135], v[168:171], v[8:11], 0
    ds_read_b128 v[168:171], v204 offset:8192
    s_waitcnt lgkmcnt(3)
    v_mfma_f32_32x32x16_bf16 v[120:135], v[172:175], v[12:15], v[120:135]
    ds_read_b128 v[172:175], v205 offset:8192
    s_waitcnt lgkmcnt(3)
    v_mfma_f32_32x32x16_bf16 v[120:135], v[176:179], v[16:19], v[120:135]
    ds_read_b128 v[176:179], v206 offset:8192
    s_waitcnt lgkmcnt(3)
    v_mfma_f32_32x32x16_bf16 v[120:135], v[180:183], v[20:23], v[120:135]
    ds_read_b128 v[180:183], v207 offset:8192
    s_waitcnt lgkmcnt(3)
    v_mfma_f32_32x32x16_bf16 v[120:135], v[168:171], v[24:27], v[120:135]
    s_waitcnt lgkmcnt(2)
    v_mfma_f32_32x32x16_bf16 v[120:135], v[172:175], v[28:31], v[120:135]
    s_waitcnt lgkmcnt(1)
    v_mfma_f32_32x32x16_bf16 v[120:135], v[176:179], v[32:35], v[120:135]
    s_waitcnt lgkmcnt(0)
    v_mfma_f32_32x32x16_bf16 v[120:135], v[180:183], v[36:39], v[120:135]
    s_mov_b32 s70, 0
    s_nop 10
attn_kernel_loop:
    s_cmp_eq_u32 s70, 7
    s_cbranch_scc1 attn_kernel_w0t
    s_waitcnt vmcnt(8)
    s_branch attn_kernel_w0d
attn_kernel_w0t:
    s_waitcnt vmcnt(8)
attn_kernel_w0d:
    s_barrier
    s_cmp_eq_u32 s70, 3
    s_cbranch_scc0 attn_kernel_ns0
    s_mov_b32 s60, s44
    s_mov_b32 s61, s45
    s_mov_b32 s62, s46
    s_mov_b32 s63, s47
    s_mov_b32 s68, 0
attn_kernel_ns0:
    s_cmp_eq_u32 s70, 7
    s_cbranch_scc1 attn_kernel_nd0
    s_add_u32 m0, s29, 0
    s_nop 0
    buffer_load_dwordx4 v212, s[60:63], s68 offen lds
    buffer_load_dwordx4 v213, s[60:63], s68 offen offset:1024 lds
    s_add_u32 s68, s68, 16384
    s_add_u32 m0, s29, 114688
    s_nop 0
    buffer_load_dwordx4 v214, s[64:67], s69 offen lds
    buffer_load_dwordx4 v214, s[64:67], s69 offen offset:1024 lds
    s_add_u32 s69, s69, 16384
    s_branch attn_kernel_nd0b
attn_kernel_nd0:
    s_add_u32 m0, s29, 114688
    s_nop 0
    buffer_load_dwordx4 v214, s[64:67], s69 offen lds
    buffer_load_dwordx4 v214, s[64:67], s69 offen offset:1024 lds
    s_add_u32 s69, s69, 16384
attn_kernel_nd0b:
    ds_read_b128 v[168:171], v200 offset:16384
    ds_read_b128 v[172:175], v201 offset:16384
    ds_read_b128 v[176:179], v202 offset:16384
    ds_read_b128 v[180:183], v203 offset:16384
    s_waitcnt lgkmcnt(3)
    v_mfma_f32_32x32x16_bf16 v[136:151], v[168:171], v[8:11], 0
    v_max3_f32 v220, v104, v105, v106
    v_max3_f32 v220, v220, v107, v108
    v_max3_f32 v220, v220, v109, v110
    v_max3_f32 v220, v220, v111, v112
    v_max3_f32 v220, v220, v113, v114
    ds_read_b128 v[168:171], v204 offset:16384
    s_waitcnt lgkmcnt(3)
    v_mfma_f32_32x32x16_bf16 v[136:151], v[172:175], v[12:15], v[136:151]
    v_max3_f32 v220, v220, v115, v116
    v_max3_f32 v220, v220, v117, v118
    v_max3_f32 v220, v220, v119, v120
    v_max3_f32 v220, v220, v121, v122
    v_max3_f32 v220, v220, v123, v124
    ds_read_b128 v[172:175], v205 offset:16384
    s_waitcnt lgkmcnt(3)
    v_mfma_f32_32x32x16_bf16 v[136:151], v[176:179], v[16:19], v[136:151]
    v_max3_f32 v220, v220, v125, v126
    v_max3_f32 v220, v220, v127, v128
    v_max3_f32 v220, v220, v129, v130
    v_max3_f32 v220, v220, v131, v132
    v_max3_f32 v220, v220, v133, v134
    v_max_f32 v220, v220, v135
    v_cmp_gt_f32 vcc, v220, v218
    s_nop 4
    s_cbranch_vccnz attn_kernel_slow1
attn_kernel_back1:
    ds_read_b128 v[176:179], v206 offset:16384
    s_waitcnt lgkmcnt(3)
    v_mfma_f32_32x32x16_bf16 v[136:151], v[180:183], v[20:23], v[136:151]
    v_fma_f32 v104, v104, s30, -v217
    v_exp_f32 v104, v104
    v_fma_f32 v105, v105, s30, -v217
    v_exp_f32 v105, v105
    v_fma_f32 v106, v106, s30, -v217
    v_exp_f32 v106, v106
    v_fma_f32 v107, v107, s30, -v217
    v_exp_f32 v107, v107
    ds_read_b128 v[180:183], v207 offset:16384
    s_waitcnt lgkmcnt(3)
    v_mfma_f32_32x32x16_bf16 v[136:151], v[168:171], v[24:27], v[136:151]
    v_add_f32 v216, v216, v104
    v_add_f32 v224, v224, v105
    v_cvt_pk_bf16_f32 v104, v104, v105
    v_fma_f32 v108, v108, s30, -v217
    v_exp_f32 v108, v108
    v_fma_f32 v109, v109, s30, -v217
    v_exp_f32 v109, v109
    v_add_f32 v225, v225, v106
    v_add_f32 v226, v226, v107
    ds_read_b128 v[168:171], v200 offset:24576
    s_waitcnt lgkmcnt(3)
    v_mfma_f32_32x32x16_bf16 v[136:151], v[172:175], v[28:31], v[136:151]
    v_cvt_pk_bf16_f32 v105, v106, v107
    v_fma_f32 v110, v110, s30, -v217
    v_exp_f32 v110, v110
    v_fma_f32 v111, v111, s30, -v217
    v_exp_f32 v111, v111
    v_add_f32 v216, v216, v108
    v_add_f32 v224, v224, v109
    v_cvt_pk_bf16_f32 v106, v108, v109
    ds_read_b128 v[172:175], v201 offset:24576
    s_waitcnt lgkmcnt(3)
    v_mfma_f32_32x32x16_bf16 v[136:151], v[176:179], v[32:35], v[136:151]
    v_fma_f32 v112, v112, s30, -v217
    v_exp_f32 v112, v112
    v_fma_f32 v113, v113, s30, -v217
    v_exp_f32 v113, v113
    v_add_f32 v225, v225, v110
    v_add_f32 v226, v226, v111
    v_cvt_pk_bf16_f32 v107, v110, v111
    v_fma_f32 v114, v114, s30, -v217
    v_exp_f32 v114, v114
    ds_read_b128 v[176:179], v202 offset:24576
    s_waitcnt lgkmcnt(3)
    v_mfma_f32_32x32x16_bf16 v[136:151], v[180:183], v[36:39], v[136:151]
    v_fma_f32 v115, v115, s30, -v217
    v_exp_f32 v115, v115
    v_add_f32 v216, v216, v112
    v_add_f32 v224, v224, v113
    v_cvt_pk_bf16_f32 v108, v112, v113
    v_fma_f32 v116, v116, s30, -v217
    v_exp_f32 v116, v116
    v_fma_f32 v117, v117, s30, -v217
    v_exp_f32 v117, v117
    ds_read_b128 v[180:183], v203 offset:24576
    s_waitcnt lgkmcnt(3)
    v_mfma_f32_32x32x16_bf16 v[152:167], v[168:171], v[8:11], 0
    v_add_f32 v225, v225, v114
    v_add_f32 v226, v226, v115
    v_cvt_pk_bf16_f32 v109, v114, v115
    v_fma_f32 v118, v118, s30, -v217
    v_exp_f32 v118, v118
    v_fma_f32 v119, v119, s30, -v217
    v_exp_f32 v119, v119
    v_add_f32 v216, v216, v116
    ds_read_b128 v[168:171], v204 offset:24576
    s_waitcnt lgkmcnt(3)
    v_mfma_f32_32x32x16_bf16 v[152:167], v[172:175], v[12:15], v[152:167]
    v_add_f32 v224, v224, v117
    v_cvt_pk_bf16_f32 v110, v116, v117
    v_fma_f32 v120, v120, s30, -v217
    v_exp_f32 v120, v120
    v_fma_f32 v121, v121, s30, -v217
    v_exp_f32 v121, v121
    v_add_f32 v225, v225, v118
    v_add_f32 v226, v226, v119
    v_cvt_pk_bf16_f32 v111, v118, v119
    ds_read_b128 v[172:175], v205 offset:24576
    s_waitcnt lgkmcnt(3)
    v_mfma_f32_32x32x16_bf16 v[152:167], v[176:179], v[16:19], v[152:167]
    v_fma_f32 v122, v122, s30, -v217
    v_exp_f32 v122, v122
    v_fma_f32 v123, v123, s30, -v217
    v_exp_f32 v123, v123
    v_add_f32 v216, v216, v120
    v_add_f32 v224, v224, v121
    v_cvt_pk_bf16_f32 v112, v120, v121
    v_fma_f32 v124, v124, s30, -v217
    ds_read_b128 v[176:179], v206 offset:24576
    s_waitcnt lgkmcnt(3)
    v_mfma_f32_32x32x16_bf16 v[152:167], v[180:183], v[20:23], v[152:167]
    v_exp_f32 v124, v124
    v_fma_f32 v125, v125, s30, -v217
    v_exp_f32 v125, v125
    v_add_f32 v225, v225, v122
    v_add_f32 v226, v226, v123
    v_cvt_pk_bf16_f32 v113, v122, v123
    v_fma_f32 v126, v126, s30, -v217
    v_exp_f32 v126, v126
    v_fma_f32 v127, v127, s30, -v217
    ds_read_b128 v[180:183], v207 offset:24576
    s_waitcnt lgkmcnt(3)
    v_mfma_f32_32x32x16_bf16 v[152:167], v[168:171], v[24:27], v[152:167]
    v_exp_f32 v127, v127
    v_add_f32 v216, v216, v124
    v_add_f32 v224, v224, v125
    v_cvt_pk_bf16_f32 v114, v124, v125
    v_fma_f32 v128, v128, s30, -v217
    v_exp_f32 v128, v128
    v_fma_f32 v129, v129, s30, -v217
    v_exp_f32 v129, v129
    v_add_f32 v225, v225, v126
    s_waitcnt lgkmcnt(2)
    v_mfma_f32_32x32x16_bf16 v[152:167], v[172:175], v[28:31], v[152:167]
    v_add_f32 v226, v226, v127
    v_cvt_pk_bf16_f32 v115, v126, v127
    v_fma_f32 v130, v130, s30, -v217
    v_exp_f32 v130, v130
    v_fma_f32 v131, v131, s30, -v217
    v_exp_f32 v131, v131
    v_add_f32 v216, v216, v128
    v_add_f32 v224, v224, v129
    s_waitcnt lgkmcnt(1)
    v_mfma_f32_32x32x16_bf16 v[152:167], v[176:179], v[32:35], v[152:167]
    v_cvt_pk_bf16_f32 v116, v128, v129
    v_fma_f32 v132, v132, s30, -v217
    v_exp_f32 v132, v132
    v_fma_f32 v133, v133, s30, -v217
    v_exp_f32 v133, v133
    v_add_f32 v225, v225, v130
    v_add_f32 v226, v226, v131
    v_cvt_pk_bf16_f32 v117, v130, v131
    v_fma_f32 v134, v134, s30, -v217
    s_waitcnt lgkmcnt(0)
    v_mfma_f32_32x32x16_bf16 v[152:167], v[180:183], v[36:39], v[152:167]
    v_exp_f32 v134, v134
    v_fma_f32 v135, v135, s30, -v217
    v_exp_f32 v135, v135
    v_add_f32 v216, v216, v132
    v_add_f32 v224, v224, v133
    v_cvt_pk_bf16_f32 v118, v132, v133
    v_add_f32 v225, v225, v134
    v_add_f32 v226, v226, v135
    v_cvt_pk_bf16_f32 v119, v134, v135
    ds_read_b64_tr_b16 v[184:185], v208 offset:0
    ds_read_b64_tr_b16 v[186:187], v208 offset:2048
    ds_read_b64_tr_b16 v[188:189], v209 offset:0
    ds_read_b64_tr_b16 v[190:191], v209 offset:2048
    ds_read_b64_tr_b16 v[192:193], v210 offset:0
    ds_read_b64_tr_b16 v[194:195], v210 offset:2048
    ds_read_b64_tr_b16 v[196:197], v211 offset:0
    ds_read_b64_tr_b16 v[198:199], v211 offset:2048
    s_waitcnt lgkmcnt(6)
    v_mfma_f32_32x32x16_bf16 v[40:55], v[184:187], v[104:107], v[40:55]
    ds_read_b64_tr_b16 v[184:185], v208 offset:4096
    ds_read_b64_tr_b16 v[186:187], v208 offset:6144
    s_waitcnt lgkmcnt(6)
    v_mfma_f32_32x32x16_bf16 v[56:71], v[188:191], v[104:107], v[56:71]
    ds_read_b64_tr_b16 v[188:189], v209 offset:4096
    ds_read_b64_tr_b16 v[190:191], v209 offset:6144
    s_waitcnt lgkmcnt(6)
    v_mfma_f32_32x32x16_bf16 v[72:87], v[192:195], v[104:107], v[72:87]
    ds_read_b64_tr_b16 v[192:193], v210 offset:4096
    ds_read_b64_tr_b16 v[194:195], v210 offset:6144
    s_waitcnt lgkmcnt(6)
    v_mfma_f32_32x32x16_bf16 v[88:103], v[196:199], v[104:107], v[88:103]
    ds_read_b64_tr_b16 v[196:197], v211 offset:4096
    ds_read_b64_tr_b16 v[198:199], v211 offset:6144
    s_waitcnt lgkmcnt(6)
    v_mfma_f32_32x32x16_bf16 v[40:55], v[184:187], v[108:111], v[40:55]
    ds_read_b64_tr_b16 v[184:185], v208 offset:8192
    ds_read_b64_tr_b16 v[186:187], v208 offset:10240
    s_waitcnt lgkmcnt(6)
    v_mfma_f32_32x32x16_bf16 v[56:71], v[188:191], v[108:111], v[56:71]
    ds_read_b64_tr_b16 v[188:189], v209 offset:8192
    ds_read_b64_tr_b16 v[190:191], v209 offset:10240
    s_waitcnt lgkmcnt(6)
    v_mfma_f32_32x32x16_bf16 v[72:87], v[192:195], v[108:111], v[72:87]
    ds_read_b64_tr_b16 v[192:193], v210 offset:8192
    ds_read_b64_tr_b16 v[194:195], v210 offset:10240
    s_waitcnt lgkmcnt(6)
    v_mfma_f32_32x32x16_bf16 v[88:103], v[196:199], v[108:111], v[88:103]
    ds_read_b64_tr_b16 v[196:197], v211 offset:8192
    ds_read_b64_tr_b16 v[198:199], v211 offset:10240
    s_waitcnt lgkmcnt(6)
    v_mfma_f32_32x32x16_bf16 v[40:55], v[184:187], v[112:115], v[40:55]
    ds_read_b64_tr_b16 v[184:185], v208 offset:12288
    ds_read_b64_tr_b16 v[186:187], v208 offset:14336
    s_waitcnt lgkmcnt(6)
    v_mfma_f32_32x32x16_bf16 v[56:71], v[188:191], v[112:115], v[56:71]
    ds_read_b64_tr_b16 v[188:189], v209 offset:12288
    ds_read_b64_tr_b16 v[190:191], v209 offset:14336
    s_waitcnt lgkmcnt(6)
    v_mfma_f32_32x32x16_bf16 v[72:87], v[192:195], v[112:115], v[72:87]
    ds_read_b64_tr_b16 v[192:193], v210 offset:12288
    ds_read_b64_tr_b16 v[194:195], v210 offset:14336
    s_waitcnt lgkmcnt(6)
    v_mfma_f32_32x32x16_bf16 v[88:103], v[196:199], v[112:115], v[88:103]
    ds_read_b64_tr_b16 v[196:197], v211 offset:12288
    ds_read_b64_tr_b16 v[198:199], v211 offset:14336
    s_waitcnt lgkmcnt(6)
    v_mfma_f32_32x32x16_bf16 v[40:55], v[184:187], v[116:119], v[40:55]
    s_waitcnt lgkmcnt(4)
    v_mfma_f32_32x32x16_bf16 v[56:71], v[188:191], v[116:119], v[56:71]
    s_waitcnt lgkmcnt(2)
    v_mfma_f32_32x32x16_bf16 v[72:87], v[192:195], v[116:119], v[72:87]
    s_waitcnt lgkmcnt(0)
    v_mfma_f32_32x32x16_bf16 v[88:103], v[196:199], v[116:119], v[88:103]
    s_cmp_eq_u32 s70, 7
    s_nop 10
    s_cbranch_scc1 attn_kernel_w1t
    s_waitcnt vmcnt(8)
    s_branch attn_kernel_w1d
attn_kernel_w1t:
    s_waitcnt vmcnt(6)
attn_kernel_w1d:
    s_barrier
    s_cmp_eq_u32 s70, 3
    s_cbranch_scc0 attn_kernel_ns1
    s_mov_b32 s64, s48
    s_mov_b32 s65, s49
    s_mov_b32 s66, s50
    s_mov_b32 s67, s51
    s_mov_b32 s69, 0
attn_kernel_ns1:
    s_cmp_eq_u32 s70, 7
    s_cbranch_scc1 attn_kernel_nd1
    s_add_u32 m0, s29, 16384
    s_nop 0
    buffer_load_dwordx4 v212, s[60:63], s68 offen lds
    buffer_load_dwordx4 v213, s[60:63], s68 offen offset:1024 lds
    s_add_u32 s68, s68, 16384
    s_add_u32 m0, s29, 65536
    s_nop 0
    buffer_load_dwordx4 v214, s[64:67], s69 offen lds
    buffer_load_dwordx4 v214, s[64:67], s69 offen offset:1024 lds
    s_add_u32 s69, s69, 16384
attn_kernel_nd1:
    ds_read_b128 v[168:171], v200 offset:32768
    ds_read_b128 v[172:175], v201 offset:32768
    ds_read_b128 v[176:179], v202 offset:32768
    ds_read_b128 v[180:183], v203 offset:32768
    s_waitcnt lgkmcnt(3)
    v_mfma_f32_32x32x16_bf16 v[104:119], v[168:171], v[8:11], 0
    v_max3_f32 v220, v136, v137, v138
    v_max3_f32 v220, v220, v139, v140
    v_max3_f32 v220, v220, v141, v142
    v_max3_f32 v220, v220, v143, v144
    v_max3_f32 v220, v220, v145, v146
    ds_read_b128 v[168:171], v204 offset:32768
    s_waitcnt lgkmcnt(3)
    v_mfma_f32_32x32x16_bf16 v[104:119], v[172:175], v[12:15], v[104:119]
    v_max3_f32 v220, v220, v147, v148
    v_max3_f32 v220, v220, v149, v150
    v_max3_f32 v220, v220, v151, v152
    v_max3_f32 v220, v220, v153, v154
    v_max3_f32 v220, v220, v155, v156
    ds_read_b128 v[172:175], v205 offset:32768
    s_waitcnt lgkmcnt(3)
    v_mfma_f32_32x32x16_bf16 v[104:119], v[176:179], v[16:19], v[104:119]
    v_max3_f32 v220, v220, v157, v158
    v_max3_f32 v220, v220, v159, v160
    v_max3_f32 v220, v220, v161, v162
    v_max3_f32 v220, v220, v163, v164
    v_max3_f32 v220, v220, v165, v166
    v_max_f32 v220, v220, v167
    v_cmp_gt_f32 vcc, v220, v218
    s_nop 4
    s_cbranch_vccnz attn_kernel_slow2
attn_kernel_back2:
    ds_read_b128 v[176:179], v206 offset:32768
    s_waitcnt lgkmcnt(3)
    v_mfma_f32_32x32x16_bf16 v[104:119], v[180:183], v[20:23], v[104:119]
    v_fma_f32 v136, v136, s30, -v217
    v_exp_f32 v136, v136
    v_fma_f32 v137, v137, s30, -v217
    v_exp_f32 v137, v137
    v_fma_f32 v138, v138, s30, -v217
    v_exp_f32 v138, v138
    v_fma_f32 v139, v139, s30, -v217
    v_exp_f32 v139, v139
    ds_read_b128 v[180:183], v207 offset:32768
    s_waitcnt lgkmcnt(3)
    v_mfma_f32_32x32x16_bf16 v[104:119], v[168:171], v[24:27], v[104:119]
    v_add_f32 v216, v216, v136
    v_add_f32 v224, v224, v137
    v_cvt_pk_bf16_f32 v136, v136, v137
    v_fma_f32 v140, v140, s30, -v217
    v_exp_f32 v140, v140
    v_fma_f32 v141, v141, s30, -v217
    v_exp_f32 v141, v141
    v_add_f32 v225, v225, v138
    v_add_f32 v226, v226, v139
    ds_read_b128 v[168:171], v200 offset:40960
    s_waitcnt lgkmcnt(3)
    v_mfma_f32_32x32x16_bf16 v[104:119], v[172:175], v[28:31], v[104:119]
    v_cvt_pk_bf16_f32 v137, v138, v139
    v_fma_f32 v142, v142, s30, -v217
    v_exp_f32 v142, v142
    v_fma_f32 v143, v143, s30, -v217
    v_exp_f32 v143, v143
    v_add_f32 v216, v216, v140
    v_add_f32 v224, v224, v141
    v_cvt_pk_bf16_f32 v138, v140, v141
    ds_read_b128 v[172:175], v201 offset:40960
    s_waitcnt lgkmcnt(3)
    v_mfma_f32_32x32x16_bf16 v[104:119], v[176:179], v[32:35], v[104:119]
    v_fma_f32 v144, v144, s30, -v217
    v_exp_f32 v144, v144
    v_fma_f32 v145, v145, s30, -v217
    v_exp_f32 v145, v145
    v_add_f32 v225, v225, v142
    v_add_f32 v226, v226, v143
    v_cvt_pk_bf16_f32 v139, v142, v143
    v_fma_f32 v146, v146, s30, -v217
    v_exp_f32 v146, v146
    ds_read_b128 v[176:179], v202 offset:40960
    s_waitcnt lgkmcnt(3)
    v_mfma_f32_32x32x16_bf16 v[104:119], v[180:183], v[36:39], v[104:119]
    v_fma_f32 v147, v147, s30, -v217
    v_exp_f32 v147, v147
    v_add_f32 v216, v216, v144
    v_add_f32 v224, v224, v145
    v_cvt_pk_bf16_f32 v140, v144, v145
    v_fma_f32 v148, v148, s30, -v217
    v_exp_f32 v148, v148
    v_fma_f32 v149, v149, s30, -v217
    v_exp_f32 v149, v149
    ds_read_b128 v[180:183], v203 offset:40960
    s_waitcnt lgkmcnt(3)
    v_mfma_f32_32x32x16_bf16 v[120:135], v[168:171], v[8:11], 0
    v_add_f32 v225, v225, v146
    v_add_f32 v226, v226, v147
    v_cvt_pk_bf16_f32 v141, v146, v147
    v_fma_f32 v150, v150, s30, -v217
    v_exp_f32 v150, v150
    v_fma_f32 v151, v151, s30, -v217
    v_exp_f32 v151, v151
    v_add_f32 v216, v216, v148
    ds_read_b128 v[168:171], v204 offset:40960
    s_waitcnt lgkmcnt(3)
    v_mfma_f32_32x32x16_bf16 v[120:135], v[172:175], v[12:15], v[120:135]
    v_add_f32 v224, v224, v149
    v_cvt_pk_bf16_f32 v142, v148, v149
    v_fma_f32 v152, v152, s30, -v217
    v_exp_f32 v152, v152
    v_fma_f32 v153, v153, s30, -v217
    v_exp_f32 v153, v153
    v_add_f32 v225, v225, v150
    v_add_f32 v226, v226, v151
    v_cvt_pk_bf16_f32 v143, v150, v151
    ds_read_b128 v[172:175], v205 offset:40960
    s_waitcnt lgkmcnt(3)
    v_mfma_f32_32x32x16_bf16 v[120:135], v[176:179], v[16:19], v[120:135]
    v_fma_f32 v154, v154, s30, -v217
    v_exp_f32 v154, v154
    v_fma_f32 v155, v155, s30, -v217
    v_exp_f32 v155, v155
    v_add_f32 v216, v216, v152
    v_add_f32 v224, v224, v153
    v_cvt_pk_bf16_f32 v144, v152, v153
    v_fma_f32 v156, v156, s30, -v217
    ds_read_b128 v[176:179], v206 offset:40960
    s_waitcnt lgkmcnt(3)
    v_mfma_f32_32x32x16_bf16 v[120:135], v[180:183], v[20:23], v[120:135]
    v_exp_f32 v156, v156
    v_fma_f32 v157, v157, s30, -v217
    v_exp_f32 v157, v157
    v_add_f32 v225, v225, v154
    v_add_f32 v226, v226, v155
    v_cvt_pk_bf16_f32 v145, v154, v155
    v_fma_f32 v158, v158, s30, -v217
    v_exp_f32 v158, v158
    v_fma_f32 v159, v159, s30, -v217
    ds_read_b128 v[180:183], v207 offset:40960
    s_waitcnt lgkmcnt(3)
    v_mfma_f32_32x32x16_bf16 v[120:135], v[168:171], v[24:27], v[120:135]
    v_exp_f32 v159, v159
    v_add_f32 v216, v216, v156
    v_add_f32 v224, v224, v157
    v_cvt_pk_bf16_f32 v146, v156, v157
    v_fma_f32 v160, v160, s30, -v217
    v_exp_f32 v160, v160
    v_fma_f32 v161, v161, s30, -v217
    v_exp_f32 v161, v161
    v_add_f32 v225, v225, v158
    s_waitcnt lgkmcnt(2)
    v_mfma_f32_32x32x16_bf16 v[120:135], v[172:175], v[28:31], v[120:135]
    v_add_f32 v226, v226, v159
    v_cvt_pk_bf16_f32 v147, v158, v159
    v_fma_f32 v162, v162, s30, -v217
    v_exp_f32 v162, v162
    v_fma_f32 v163, v163, s30, -v217
    v_exp_f32 v163, v163
    v_add_f32 v216, v216, v160
    v_add_f32 v224, v224, v161
    s_waitcnt lgkmcnt(1)
    v_mfma_f32_32x32x16_bf16 v[120:135], v[176:179], v[32:35], v[120:135]
    v_cvt_pk_bf16_f32 v148, v160, v161
    v_fma_f32 v164, v164, s30, -v217
    v_exp_f32 v164, v164
    v_fma_f32 v165, v165, s30, -v217
    v_exp_f32 v165, v165
    v_add_f32 v225, v225, v162
    v_add_f32 v226, v226, v163
    v_cvt_pk_bf16_f32 v149, v162, v163
    v_fma_f32 v166, v166, s30, -v217
    s_waitcnt lgkmcnt(0)
    v_mfma_f32_32x32x16_bf16 v[120:135], v[180:183], v[36:39], v[120:135]
    v_exp_f32 v166, v166
    v_fma_f32 v167, v167, s30, -v217
    v_exp_f32 v167, v167
    v_add_f32 v216, v216, v164
    v_add_f32 v224, v224, v165
    v_cvt_pk_bf16_f32 v150, v164, v165
    v_add_f32 v225, v225, v166
    v_add_f32 v226, v226, v167
    v_cvt_pk_bf16_f32 v151, v166, v167
    ds_read_b64_tr_b16 v[184:185], v208 offset:16384
    ds_read_b64_tr_b16 v[186:187], v208 offset:18432
    ds_read_b64_tr_b16 v[188:189], v209 offset:16384
    ds_read_b64_tr_b16 v[190:191], v209 offset:18432
    ds_read_b64_tr_b16 v[192:193], v210 offset:16384
    ds_read_b64_tr_b16 v[194:195], v210 offset:18432
    ds_read_b64_tr_b16 v[196:197], v211 offset:16384
    ds_read_b64_tr_b16 v[198:199], v211 offset:18432
    s_waitcnt lgkmcnt(6)
    v_mfma_f32_32x32x16_bf16 v[40:55], v[184:187], v[136:139], v[40:55]
    ds_read_b64_tr_b16 v[184:185], v208 offset:20480
    ds_read_b64_tr_b16 v[186:187], v208 offset:22528
    s_waitcnt lgkmcnt(6)
    v_mfma_f32_32x32x16_bf16 v[56:71], v[188:191], v[136:139], v[56:71]
    ds_read_b64_tr_b16 v[188:189], v209 offset:20480
    ds_read_b64_tr_b16 v[190:191], v209 offset:22528
    s_waitcnt lgkmcnt(6)
    v_mfma_f32_32x32x16_bf16 v[72:87], v[192:195], v[136:139], v[72:87]
    ds_read_b64_tr_b16 v[192:193], v210 offset:20480
    ds_read_b64_tr_b16 v[194:195], v210 offset:22528
    s_waitcnt lgkmcnt(6)
    v_mfma_f32_32x32x16_bf16 v[88:103], v[196:199], v[136:139], v[88:103]
    ds_read_b64_tr_b16 v[196:197], v211 offset:20480
    ds_read_b64_tr_b16 v[198:199], v211 offset:22528
    s_waitcnt lgkmcnt(6)
    v_mfma_f32_32x32x16_bf16 v[40:55], v[184:187], v[140:143], v[40:55]
    ds_read_b64_tr_b16 v[184:185], v208 offset:24576
    ds_read_b64_tr_b16 v[186:187], v208 offset:26624
    s_waitcnt lgkmcnt(6)
    v_mfma_f32_32x32x16_bf16 v[56:71], v[188:191], v[140:143], v[56:71]
    ds_read_b64_tr_b16 v[188:189], v209 offset:24576
    ds_read_b64_tr_b16 v[190:191], v209 offset:26624
    s_waitcnt lgkmcnt(6)
    v_mfma_f32_32x32x16_bf16 v[72:87], v[192:195], v[140:143], v[72:87]
    ds_read_b64_tr_b16 v[192:193], v210 offset:24576
    ds_read_b64_tr_b16 v[194:195], v210 offset:26624
    s_waitcnt lgkmcnt(6)
    v_mfma_f32_32x32x16_bf16 v[88:103], v[196:199], v[140:143], v[88:103]
    ds_read_b64_tr_b16 v[196:197], v211 offset:24576
    ds_read_b64_tr_b16 v[198:199], v211 offset:26624
    s_waitcnt lgkmcnt(6)
    v_mfma_f32_32x32x16_bf16 v[40:55], v[184:187], v[144:147], v[40:55]
    ds_read_b64_tr_b16 v[184:185], v208 offset:28672
    ds_read_b64_tr_b16 v[186:187], v208 offset:30720
    s_waitcnt lgkmcnt(6)
    v_mfma_f32_32x32x16_bf16 v[56:71], v[188:191], v[144:147], v[56:71]
    ds_read_b64_tr_b16 v[188:189], v209 offset:28672
    ds_read_b64_tr_b16 v[190:191], v209 offset:30720
    s_waitcnt lgkmcnt(6)
    v_mfma_f32_32x32x16_bf16 v[72:87], v[192:195], v[144:147], v[72:87]
    ds_read_b64_tr_b16 v[192:193], v210 offset:28672
    ds_read_b64_tr_b16 v[194:195], v210 offset:30720
    s_waitcnt lgkmcnt(6)
    v_mfma_f32_32x32x16_bf16 v[88:103], v[196:199], v[144:147], v[88:103]
    ds_read_b64_tr_b16 v[196:197], v211 offset:28672
    ds_read_b64_tr_b16 v[198:199], v211 offset:30720
    s_waitcnt lgkmcnt(6)
    v_mfma_f32_32x32x16_bf16 v[40:55], v[184:187], v[148:151], v[40:55]
    s_waitcnt lgkmcnt(4)
    v_mfma_f32_32x32x16_bf16 v[56:71], v[188:191], v[148:151], v[56:71]
    s_waitcnt lgkmcnt(2)
    v_mfma_f32_32x32x16_bf16 v[72:87], v[192:195], v[148:151], v[72:87]
    s_waitcnt lgkmcnt(0)
    v_mfma_f32_32x32x16_bf16 v[88:103], v[196:199], v[148:151], v[88:103]
    s_cmp_eq_u32 s70, 7
    s_nop 10
    s_cbranch_scc1 attn_kernel_w2t
    s_waitcnt vmcnt(8)
    s_branch attn_kernel_w2d
attn_kernel_w2t:
    s_waitcnt vmcnt(2)
attn_kernel_w2d:
    s_barrier
    ds_read_b128 v[168:171], v200 offset:49152
    ds_read_b128 v[172:175], v201 offset:49152
    ds_read_b128 v[176:179], v202 offset:49152
    ds_read_b128 v[180:183], v203 offset:49152
    s_waitcnt lgkmcnt(3)
    v_mfma_f32_32x32x16_bf16 v[136:151], v[168:171], v[8:11], 0
    v_max3_f32 v220, v104, v105, v106
    v_max3_f32 v220, v220, v107, v108
    v_max3_f32 v220, v220, v109, v110
    v_max3_f32 v220, v220, v111, v112
    v_max3_f32 v220, v220, v113, v114
    ds_read_b128 v[168:171], v204 offset:49152
    s_waitcnt lgkmcnt(3)
    v_mfma_f32_32x32x16_bf16 v[136:151], v[172:175], v[12:15], v[136:151]
    v_max3_f32 v220, v220, v115, v116
    v_max3_f32 v220, v220, v117, v118
    v_max3_f32 v220, v220, v119, v120
    v_max3_f32 v220, v220, v121, v122
    v_max3_f32 v220, v220, v123, v124
    ds_read_b128 v[172:175], v205 offset:49152
    s_waitcnt lgkmcnt(3)
    v_mfma_f32_32x32x16_bf16 v[136:151], v[176:179], v[16:19], v[136:151]
    v_max3_f32 v220, v220, v125, v126
    v_max3_f32 v220, v220, v127, v128
    v_max3_f32 v220, v220, v129, v130
    v_max3_f32 v220, v220, v131, v132
    v_max3_f32 v220, v220, v133, v134
    v_max_f32 v220, v220, v135
    v_cmp_gt_f32 vcc, v220, v218
    s_nop 4
    s_cbranch_vccnz attn_kernel_slow3
attn_kernel_back3:
    ds_read_b128 v[176:179], v206 offset:49152
    s_waitcnt lgkmcnt(3)
    v_mfma_f32_32x32x16_bf16 v[136:151], v[180:183], v[20:23], v[136:151]
    v_fma_f32 v104, v104, s30, -v217
    v_exp_f32 v104, v104
    v_fma_f32 v105, v105, s30, -v217
    v_exp_f32 v105, v105
    v_fma_f32 v106, v106, s30, -v217
    v_exp_f32 v106, v106
    v_fma_f32 v107, v107, s30, -v217
    v_exp_f32 v107, v107
    ds_read_b128 v[180:183], v207 offset:49152
    s_waitcnt lgkmcnt(3)
    v_mfma_f32_32x32x16_bf16 v[136:151], v[168:171], v[24:27], v[136:151]
    v_add_f32 v216, v216, v104
    v_add_f32 v224, v224, v105
    v_cvt_pk_bf16_f32 v104, v104, v105
    v_fma_f32 v108, v108, s30, -v217
    v_exp_f32 v108, v108
    v_fma_f32 v109, v109, s30, -v217
    v_exp_f32 v109, v109
    v_add_f32 v225, v225, v106
    v_add_f32 v226, v226, v107
    ds_read_b128 v[168:171], v200 offset:57344
    s_waitcnt lgkmcnt(3)
    v_mfma_f32_32x32x16_bf16 v[136:151], v[172:175], v[28:31], v[136:151]
    v_cvt_pk_bf16_f32 v105, v106, v107
    v_fma_f32 v110, v110, s30, -v217
    v_exp_f32 v110, v110
    v_fma_f32 v111, v111, s30, -v217
    v_exp_f32 v111, v111
    v_add_f32 v216, v216, v108
    v_add_f32 v224, v224, v109
    v_cvt_pk_bf16_f32 v106, v108, v109
    ds_read_b128 v[172:175], v201 offset:57344
    s_waitcnt lgkmcnt(3)
    v_mfma_f32_32x32x16_bf16 v[136:151], v[176:179], v[32:35], v[136:151]
    v_fma_f32 v112, v112, s30, -v217
    v_exp_f32 v112, v112
    v_fma_f32 v113, v113, s30, -v217
    v_exp_f32 v113, v113
    v_add_f32 v225, v225, v110
    v_add_f32 v226, v226, v111
    v_cvt_pk_bf16_f32 v107, v110, v111
    v_fma_f32 v114, v114, s30, -v217
    v_exp_f32 v114, v114
    ds_read_b128 v[176:179], v202 offset:57344
    s_waitcnt lgkmcnt(3)
    v_mfma_f32_32x32x16_bf16 v[136:151], v[180:183], v[36:39], v[136:151]
    v_fma_f32 v115, v115, s30, -v217
    v_exp_f32 v115, v115
    v_add_f32 v216, v216, v112
    v_add_f32 v224, v224, v113
    v_cvt_pk_bf16_f32 v108, v112, v113
    v_fma_f32 v116, v116, s30, -v217
    v_exp_f32 v116, v116
    v_fma_f32 v117, v117, s30, -v217
    v_exp_f32 v117, v117
    ds_read_b128 v[180:183], v203 offset:57344
    s_waitcnt lgkmcnt(3)
    v_mfma_f32_32x32x16_bf16 v[152:167], v[168:171], v[8:11], 0
    v_add_f32 v225, v225, v114
    v_add_f32 v226, v226, v115
    v_cvt_pk_bf16_f32 v109, v114, v115
    v_fma_f32 v118, v118, s30, -v217
    v_exp_f32 v118, v118
    v_fma_f32 v119, v119, s30, -v217
    v_exp_f32 v119, v119
    v_add_f32 v216, v216, v116
    ds_read_b128 v[168:171], v204 offset:57344
    s_waitcnt lgkmcnt(3)
    v_mfma_f32_32x32x16_bf16 v[152:167], v[172:175], v[12:15], v[152:167]
    v_add_f32 v224, v224, v117
    v_cvt_pk_bf16_f32 v110, v116, v117
    v_fma_f32 v120, v120, s30, -v217
    v_exp_f32 v120, v120
    v_fma_f32 v121, v121, s30, -v217
    v_exp_f32 v121, v121
    v_add_f32 v225, v225, v118
    v_add_f32 v226, v226, v119
    v_cvt_pk_bf16_f32 v111, v118, v119
    ds_read_b128 v[172:175], v205 offset:57344
    s_waitcnt lgkmcnt(3)
    v_mfma_f32_32x32x16_bf16 v[152:167], v[176:179], v[16:19], v[152:167]
    v_fma_f32 v122, v122, s30, -v217
    v_exp_f32 v122, v122
    v_fma_f32 v123, v123, s30, -v217
    v_exp_f32 v123, v123
    v_add_f32 v216, v216, v120
    v_add_f32 v224, v224, v121
    v_cvt_pk_bf16_f32 v112, v120, v121
    v_fma_f32 v124, v124, s30, -v217
    ds_read_b128 v[176:179], v206 offset:57344
    s_waitcnt lgkmcnt(3)
    v_mfma_f32_32x32x16_bf16 v[152:167], v[180:183], v[20:23], v[152:167]
    v_exp_f32 v124, v124
    v_fma_f32 v125, v125, s30, -v217
    v_exp_f32 v125, v125
    v_add_f32 v225, v225, v122
    v_add_f32 v226, v226, v123
    v_cvt_pk_bf16_f32 v113, v122, v123
    v_fma_f32 v126, v126, s30, -v217
    v_exp_f32 v126, v126
    v_fma_f32 v127, v127, s30, -v217
    ds_read_b128 v[180:183], v207 offset:57344
    s_waitcnt lgkmcnt(3)
    v_mfma_f32_32x32x16_bf16 v[152:167], v[168:171], v[24:27], v[152:167]
    v_exp_f32 v127, v127
    v_add_f32 v216, v216, v124
    v_add_f32 v224, v224, v125
    v_cvt_pk_bf16_f32 v114, v124, v125
    v_fma_f32 v128, v128, s30, -v217
    v_exp_f32 v128, v128
    v_fma_f32 v129, v129, s30, -v217
    v_exp_f32 v129, v129
    v_add_f32 v225, v225, v126
    s_waitcnt lgkmcnt(2)
    v_mfma_f32_32x32x16_bf16 v[152:167], v[172:175], v[28:31], v[152:167]
    v_add_f32 v226, v226, v127
    v_cvt_pk_bf16_f32 v115, v126, v127
    v_fma_f32 v130, v130, s30, -v217
    v_exp_f32 v130, v130
    v_fma_f32 v131, v131, s30, -v217
    v_exp_f32 v131, v131
    v_add_f32 v216, v216, v128
    v_add_f32 v224, v224, v129
    s_waitcnt lgkmcnt(1)
    v_mfma_f32_32x32x16_bf16 v[152:167], v[176:179], v[32:35], v[152:167]
    v_cvt_pk_bf16_f32 v116, v128, v129
    v_fma_f32 v132, v132, s30, -v217
    v_exp_f32 v132, v132
    v_fma_f32 v133, v133, s30, -v217
    v_exp_f32 v133, v133
    v_add_f32 v225, v225, v130
    v_add_f32 v226, v226, v131
    v_cvt_pk_bf16_f32 v117, v130, v131
    v_fma_f32 v134, v134, s30, -v217
    s_waitcnt lgkmcnt(0)
    v_mfma_f32_32x32x16_bf16 v[152:167], v[180:183], v[36:39], v[152:167]
    v_exp_f32 v134, v134
    v_fma_f32 v135, v135, s30, -v217
    v_exp_f32 v135, v135
    v_add_f32 v216, v216, v132
    v_add_f32 v224, v224, v133
    v_cvt_pk_bf16_f32 v118, v132, v133
    v_add_f32 v225, v225, v134
    v_add_f32 v226, v226, v135
    v_cvt_pk_bf16_f32 v119, v134, v135
    s_cmp_eq_u32 s70, 3
    s_nop 1
    s_cbranch_scc0 attn_kernel_nq
    buffer_load_dwordx4 v[8:11], v3, s[52:55], 0 offen offset:0
    buffer_load_dwordx4 v[12:15], v3, s[52:55], 0 offen offset:1024
    buffer_load_dwordx4 v[16:19], v3, s[52:55], 0 offen offset:2048
    buffer_load_dwordx4 v[20:23], v3, s[52:55], 0 offen offset:3072
    buffer_load_dwordx4 v[24:27], v4, s[52:55], 0 offen offset:0
    buffer_load_dwordx4 v[28:31], v4, s[52:55], 0 offen offset:1024
    buffer_load_dwordx4 v[32:35], v4, s[52:55], 0 offen offset:2048
    buffer_load_dwordx4 v[36:39], v4, s[52:55], 0 offen offset:3072
attn_kernel_nq:
    s_cmp_eq_u32 s70, 7
    s_cbranch_scc1 attn_kernel_nd2
    s_add_u32 m0, s29, 32768
    s_nop 0
    buffer_load_dwordx4 v212, s[60:63], s68 offen lds
    buffer_load_dwordx4 v213, s[60:63], s68 offen offset:1024 lds
    s_add_u32 s68, s68, 16384
    s_add_u32 m0, s29, 81920
    s_nop 0
    buffer_load_dwordx4 v214, s[64:67], s69 offen lds
    buffer_load_dwordx4 v214, s[64:67], s69 offen offset:1024 lds
    s_add_u32 s69, s69, 16384
attn_kernel_nd2:
    ds_read_b64_tr_b16 v[184:185], v208 offset:32768
    ds_read_b64_tr_b16 v[186:187], v208 offset:34816
    ds_read_b64_tr_b16 v[188:189], v209 offset:32768
    ds_read_b64_tr_b16 v[190:191], v209 offset:34816
    ds_read_b64_tr_b16 v[192:193], v210 offset:32768
    ds_read_b64_tr_b16 v[194:195], v210 offset:34816
    ds_read_b64_tr_b16 v[196:197], v211 offset:32768
    ds_read_b64_tr_b16 v[198:199], v211 offset:34816
    s_waitcnt lgkmcnt(6)
    v_mfma_f32_32x32x16_bf16 v[40:55], v[184:187], v[104:107], v[40:55]
    ds_read_b64_tr_b16 v[184:185], v208 offset:36864
    ds_read_b64_tr_b16 v[186:187], v208 offset:38912
    s_waitcnt lgkmcnt(6)
    v_mfma_f32_32x32x16_bf16 v[56:71], v[188:191], v[104:107], v[56:71]
    ds_read_b64_tr_b16 v[188:189], v209 offset:36864
    ds_read_b64_tr_b16 v[190:191], v209 offset:38912
    s_waitcnt lgkmcnt(6)
    v_mfma_f32_32x32x16_bf16 v[72:87], v[192:195], v[104:107], v[72:87]
    ds_read_b64_tr_b16 v[192:193], v210 offset:36864
    ds_read_b64_tr_b16 v[194:195], v210 offset:38912
    s_waitcnt lgkmcnt(6)
    v_mfma_f32_32x32x16_bf16 v[88:103], v[196:199], v[104:107], v[88:103]
    ds_read_b64_tr_b16 v[196:197], v211 offset:36864
    ds_read_b64_tr_b16 v[198:199], v211 offset:38912
    s_waitcnt lgkmcnt(6)
    v_mfma_f32_32x32x16_bf16 v[40:55], v[184:187], v[108:111], v[40:55]
    ds_read_b64_tr_b16 v[184:185], v208 offset:40960
    ds_read_b64_tr_b16 v[186:187], v208 offset:43008
    s_waitcnt lgkmcnt(6)
    v_mfma_f32_32x32x16_bf16 v[56:71], v[188:191], v[108:111], v[56:71]
    ds_read_b64_tr_b16 v[188:189], v209 offset:40960
    ds_read_b64_tr_b16 v[190:191], v209 offset:43008
    s_waitcnt lgkmcnt(6)
    v_mfma_f32_32x32x16_bf16 v[72:87], v[192:195], v[108:111], v[72:87]
    ds_read_b64_tr_b16 v[192:193], v210 offset:40960
    ds_read_b64_tr_b16 v[194:195], v210 offset:43008
    s_waitcnt lgkmcnt(6)
    v_mfma_f32_32x32x16_bf16 v[88:103], v[196:199], v[108:111], v[88:103]
    ds_read_b64_tr_b16 v[196:197], v211 offset:40960
    ds_read_b64_tr_b16 v[198:199], v211 offset:43008
    s_waitcnt lgkmcnt(6)
    v_mfma_f32_32x32x16_bf16 v[40:55], v[184:187], v[112:115], v[40:55]
    ds_read_b64_tr_b16 v[184:185], v208 offset:45056
    ds_read_b64_tr_b16 v[186:187], v208 offset:47104
    s_waitcnt lgkmcnt(6)
    v_mfma_f32_32x32x16_bf16 v[56:71], v[188:191], v[112:115], v[56:71]
    ds_read_b64_tr_b16 v[188:189], v209 offset:45056
    ds_read_b64_tr_b16 v[190:191], v209 offset:47104
    s_waitcnt lgkmcnt(6)
    v_mfma_f32_32x32x16_bf16 v[72:87], v[192:195], v[112:115], v[72:87]
    ds_read_b64_tr_b16 v[192:193], v210 offset:45056
    ds_read_b64_tr_b16 v[194:195], v210 offset:47104
    s_waitcnt lgkmcnt(6)
    v_mfma_f32_32x32x16_bf16 v[88:103], v[196:199], v[112:115], v[88:103]
    ds_read_b64_tr_b16 v[196:197], v211 offset:45056
    ds_read_b64_tr_b16 v[198:199], v211 offset:47104
    s_waitcnt lgkmcnt(6)
    v_mfma_f32_32x32x16_bf16 v[40:55], v[184:187], v[116:119], v[40:55]
    s_waitcnt lgkmcnt(4)
    v_mfma_f32_32x32x16_bf16 v[56:71], v[188:191], v[116:119], v[56:71]
    s_waitcnt lgkmcnt(2)
    v_mfma_f32_32x32x16_bf16 v[72:87], v[192:195], v[116:119], v[72:87]
    s_waitcnt lgkmcnt(0)
    v_mfma_f32_32x32x16_bf16 v[88:103], v[196:199], v[116:119], v[88:103]
    s_cmp_eq_u32 s70, 3
    s_nop 10
    s_cbranch_scc1 attn_kernel_w3q
    s_cmp_eq_u32 s70, 7
    s_cbranch_scc1 attn_kernel_w3t
    s_waitcnt vmcnt(8)
    s_branch attn_kernel_w3d
attn_kernel_w3q:
    s_waitcnt vmcnt(4)
    s_branch attn_kernel_w3d
attn_kernel_w3t:
    s_waitcnt vmcnt(0)
attn_kernel_w3d:
    s_barrier
    s_cmp_eq_u32 s70, 7
    s_cbranch_scc1 attn_kernel_nd3
    s_add_u32 m0, s29, 49152
    s_nop 0
    buffer_load_dwordx4 v212, s[60:63], s68 offen lds
    buffer_load_dwordx4 v213, s[60:63], s68 offen offset:1024 lds
    s_add_u32 s68, s68, 16384
    s_add_u32 m0, s29, 98304
    s_nop 0
    buffer_load_dwordx4 v214, s[64:67], s69 offen lds
    buffer_load_dwordx4 v214, s[64:67], s69 offen offset:1024 lds
    s_add_u32 s69, s69, 16384
attn_kernel_nd3:
    s_cmp_eq_u32 s70, 7
    s_cbranch_scc1 attn_kernel_noqk
    ds_read_b128 v[168:171], v200 offset:0
    ds_read_b128 v[172:175], v201 offset:0
    ds_read_b128 v[176:179], v202 offset:0
    ds_read_b128 v[180:183], v203 offset:0
    s_waitcnt lgkmcnt(3)
    v_mfma_f32_32x32x16_bf16 v[104:119], v[168:171], v[8:11], 0
    v_max3_f32 v220, v136, v137, v138
    v_max3_f32 v220, v220, v139, v140
    v_max3_f32 v220, v220, v141, v142
    v_max3_f32 v220, v220, v143, v144
    v_max3_f32 v220, v220, v145, v146
    ds_read_b128 v[168:171], v204 offset:0
    s_waitcnt lgkmcnt(3)
    v_mfma_f32_32x32x16_bf16 v[104:119], v[172:175], v[12:15], v[104:119]
    v_max3_f32 v220, v220, v147, v148
    v_max3_f32 v220, v220, v149, v150
    v_max3_f32 v220, v220, v151, v152
    v_max3_f32 v220, v220, v153, v154
    v_max3_f32 v220, v220, v155, v156
    ds_read_b128 v[172:175], v205 offset:0
    s_waitcnt lgkmcnt(3)
    v_mfma_f32_32x32x16_bf16 v[104:119], v[176:179], v[16:19], v[104:119]
    v_max3_f32 v220, v220, v157, v158
    v_max3_f32 v220, v220, v159, v160
    v_max3_f32 v220, v220, v161, v162
    v_max3_f32 v220, v220, v163, v164
    v_max3_f32 v220, v220, v165, v166
    v_max_f32 v220, v220, v167
    v_cmp_gt_f32 vcc, v220, v218
    s_nop 4
    s_cbranch_vccnz attn_kernel_slow4
attn_kernel_back4:
    ds_read_b128 v[176:179], v206 offset:0
    s_waitcnt lgkmcnt(3)
    v_mfma_f32_32x32x16_bf16 v[104:119], v[180:183], v[20:23], v[104:119]
    v_fma_f32 v136, v136, s30, -v217
    v_exp_f32 v136, v136
    v_fma_f32 v137, v137, s30, -v217
    v_exp_f32 v137, v137
    v_fma_f32 v138, v138, s30, -v217
    v_exp_f32 v138, v138
    v_fma_f32 v139, v139, s30, -v217
    v_exp_f32 v139, v139
    ds_read_b128 v[180:183], v207 offset:0
    s_waitcnt lgkmcnt(3)
    v_mfma_f32_32x32x16_bf16 v[104:119], v[168:171], v[24:27], v[104:119]
    v_add_f32 v216, v216, v136
    v_add_f32 v224, v224, v137
    v_cvt_pk_bf16_f32 v136, v136, v137
    v_fma_f32 v140, v140, s30, -v217
    v_exp_f32 v140, v140
    v_fma_f32 v141, v141, s30, -v217
    v_exp_f32 v141, v141
    v_add_f32 v225, v225, v138
    v_add_f32 v226, v226, v139
    ds_read_b128 v[168:171], v200 offset:8192
    s_waitcnt lgkmcnt(3)
    v_mfma_f32_32x32x16_bf16 v[104:119], v[172:175], v[28:31], v[104:119]
    v_cvt_pk_bf16_f32 v137, v138, v139
    v_fma_f32 v142, v142, s30, -v217
    v_exp_f32 v142, v142
    v_fma_f32 v143, v143, s30, -v217
    v_exp_f32 v143, v143
    v_add_f32 v216, v216, v140
    v_add_f32 v224, v224, v141
    v_cvt_pk_bf16_f32 v138, v140, v141
    ds_read_b128 v[172:175], v201 offset:8192
    s_waitcnt lgkmcnt(3)
    v_mfma_f32_32x32x16_bf16 v[104:119], v[176:179], v[32:35], v[104:119]
    v_fma_f32 v144, v144, s30, -v217
    v_exp_f32 v144, v144
    v_fma_f32 v145, v145, s30, -v217
    v_exp_f32 v145, v145
    v_add_f32 v225, v225, v142
    v_add_f32 v226, v226, v143
    v_cvt_pk_bf16_f32 v139, v142, v143
    v_fma_f32 v146, v146, s30, -v217
    v_exp_f32 v146, v146
    ds_read_b128 v[176:179], v202 offset:8192
    s_waitcnt lgkmcnt(3)
    v_mfma_f32_32x32x16_bf16 v[104:119], v[180:183], v[36:39], v[104:119]
    v_fma_f32 v147, v147, s30, -v217
    v_exp_f32 v147, v147
    v_add_f32 v216, v216, v144
    v_add_f32 v224, v224, v145
    v_cvt_pk_bf16_f32 v140, v144, v145
    v_fma_f32 v148, v148, s30, -v217
    v_exp_f32 v148, v148
    v_fma_f32 v149, v149, s30, -v217
    v_exp_f32 v149, v149
    ds_read_b128 v[180:183], v203 offset:8192
    s_waitcnt lgkmcnt(3)
    v_mfma_f32_32x32x16_bf16 v[120:135], v[168:171], v[8:11], 0
    v_add_f32 v225, v225, v146
    v_add_f32 v226, v226, v147
    v_cvt_pk_bf16_f32 v141, v146, v147
    v_fma_f32 v150, v150, s30, -v217
    v_exp_f32 v150, v150
    v_fma_f32 v151, v151, s30, -v217
    v_exp_f32 v151, v151
    v_add_f32 v216, v216, v148
    ds_read_b128 v[168:171], v204 offset:8192
    s_waitcnt lgkmcnt(3)
    v_mfma_f32_32x32x16_bf16 v[120:135], v[172:175], v[12:15], v[120:135]
    v_add_f32 v224, v224, v149
    v_cvt_pk_bf16_f32 v142, v148, v149
    v_fma_f32 v152, v152, s30, -v217
    v_exp_f32 v152, v152
    v_fma_f32 v153, v153, s30, -v217
    v_exp_f32 v153, v153
    v_add_f32 v225, v225, v150
    v_add_f32 v226, v226, v151
    v_cvt_pk_bf16_f32 v143, v150, v151
    ds_read_b128 v[172:175], v205 offset:8192
    s_waitcnt lgkmcnt(3)
    v_mfma_f32_32x32x16_bf16 v[120:135], v[176:179], v[16:19], v[120:135]
    v_fma_f32 v154, v154, s30, -v217
    v_exp_f32 v154, v154
    v_fma_f32 v155, v155, s30, -v217
    v_exp_f32 v155, v155
    v_add_f32 v216, v216, v152
    v_add_f32 v224, v224, v153
    v_cvt_pk_bf16_f32 v144, v152, v153
    v_fma_f32 v156, v156, s30, -v217
    ds_read_b128 v[176:179], v206 offset:8192
    s_waitcnt lgkmcnt(3)
    v_mfma_f32_32x32x16_bf16 v[120:135], v[180:183], v[20:23], v[120:135]
    v_exp_f32 v156, v156
    v_fma_f32 v157, v157, s30, -v217
    v_exp_f32 v157, v157
    v_add_f32 v225, v225, v154
    v_add_f32 v226, v226, v155
    v_cvt_pk_bf16_f32 v145, v154, v155
    v_fma_f32 v158, v158, s30, -v217
    v_exp_f32 v158, v158
    v_fma_f32 v159, v159, s30, -v217
    ds_read_b128 v[180:183], v207 offset:8192
    s_waitcnt lgkmcnt(3)
    v_mfma_f32_32x32x16_bf16 v[120:135], v[168:171], v[24:27], v[120:135]
    v_exp_f32 v159, v159
    v_add_f32 v216, v216, v156
    v_add_f32 v224, v224, v157
    v_cvt_pk_bf16_f32 v146, v156, v157
    v_fma_f32 v160, v160, s30, -v217
    v_exp_f32 v160, v160
    v_fma_f32 v161, v161, s30, -v217
    v_exp_f32 v161, v161
    v_add_f32 v225, v225, v158
    s_waitcnt lgkmcnt(2)
    v_mfma_f32_32x32x16_bf16 v[120:135], v[172:175], v[28:31], v[120:135]
    v_add_f32 v226, v226, v159
    v_cvt_pk_bf16_f32 v147, v158, v159
    v_fma_f32 v162, v162, s30, -v217
    v_exp_f32 v162, v162
    v_fma_f32 v163, v163, s30, -v217
    v_exp_f32 v163, v163
    v_add_f32 v216, v216, v160
    v_add_f32 v224, v224, v161
    s_waitcnt lgkmcnt(1)
    v_mfma_f32_32x32x16_bf16 v[120:135], v[176:179], v[32:35], v[120:135]
    v_cvt_pk_bf16_f32 v148, v160, v161
    v_fma_f32 v164, v164, s30, -v217
    v_exp_f32 v164, v164
    v_fma_f32 v165, v165, s30, -v217
    v_exp_f32 v165, v165
    v_add_f32 v225, v225, v162
    v_add_f32 v226, v226, v163
    v_cvt_pk_bf16_f32 v149, v162, v163
    v_fma_f32 v166, v166, s30, -v217
    s_waitcnt lgkmcnt(0)
    v_mfma_f32_32x32x16_bf16 v[120:135], v[180:183], v[36:39], v[120:135]
    v_exp_f32 v166, v166
    v_fma_f32 v167, v167, s30, -v217
    v_exp_f32 v167, v167
    v_add_f32 v216, v216, v164
    v_add_f32 v224, v224, v165
    v_cvt_pk_bf16_f32 v150, v164, v165
    v_add_f32 v225, v225, v166
    v_add_f32 v226, v226, v167
    v_cvt_pk_bf16_f32 v151, v166, v167
    s_nop 2
    s_branch attn_kernel_qkdone
attn_kernel_noqk:
    v_max3_f32 v220, v136, v137, v138
    v_max3_f32 v220, v220, v139, v140
    v_max3_f32 v220, v220, v141, v142
    v_max3_f32 v220, v220, v143, v144
    v_max3_f32 v220, v220, v145, v146
    v_max3_f32 v220, v220, v147, v148
    v_max3_f32 v220, v220, v149, v150
    v_max3_f32 v220, v220, v151, v152
    v_max3_f32 v220, v220, v153, v154
    v_max3_f32 v220, v220, v155, v156
    v_max3_f32 v220, v220, v157, v158
    v_max3_f32 v220, v220, v159, v160
    v_max3_f32 v220, v220, v161, v162
    v_max3_f32 v220, v220, v163, v164
    v_max3_f32 v220, v220, v165, v166
    v_max_f32 v220, v220, v167
    v_cmp_gt_f32 vcc, v220, v218
    s_nop 4
    s_cbranch_vccnz attn_kernel_slow4b
attn_kernel_back4b:
    v_fma_f32 v136, v136, s30, -v217
    v_exp_f32 v136, v136
    v_fma_f32 v137, v137, s30, -v217
    v_exp_f32 v137, v137
    v_fma_f32 v138, v138, s30, -v217
    v_exp_f32 v138, v138
    v_fma_f32 v139, v139, s30, -v217
    v_exp_f32 v139, v139
    v_add_f32 v216, v216, v136
    v_add_f32 v224, v224, v137
    v_cvt_pk_bf16_f32 v136, v136, v137
    v_fma_f32 v140, v140, s30, -v217
    v_exp_f32 v140, v140
    v_fma_f32 v141, v141, s30, -v217
    v_exp_f32 v141, v141
    v_add_f32 v225, v225, v138
    v_add_f32 v226, v226, v139
    v_cvt_pk_bf16_f32 v137, v138, v139
    v_fma_f32 v142, v142, s30, -v217
    v_exp_f32 v142, v142
    v_fma_f32 v143, v143, s30, -v217
    v_exp_f32 v143, v143
    v_add_f32 v216, v216, v140
    v_add_f32 v224, v224, v141
    v_cvt_pk_bf16_f32 v138, v140, v141
    v_fma_f32 v144, v144, s30, -v217
    v_exp_f32 v144, v144
    v_fma_f32 v145, v145, s30, -v217
    v_exp_f32 v145, v145
    v_add_f32 v225, v225, v142
    v_add_f32 v226, v226, v143
    v_cvt_pk_bf16_f32 v139, v142, v143
    v_fma_f32 v146, v146, s30, -v217
    v_exp_f32 v146, v146
    v_fma_f32 v147, v147, s30, -v217
    v_exp_f32 v147, v147
    v_add_f32 v216, v216, v144
    v_add_f32 v224, v224, v145
    v_cvt_pk_bf16_f32 v140, v144, v145
    v_fma_f32 v148, v148, s30, -v217
    v_exp_f32 v148, v148
    v_fma_f32 v149, v149, s30, -v217
    v_exp_f32 v149, v149
    v_add_f32 v225, v225, v146
    v_add_f32 v226, v226, v147
    v_cvt_pk_bf16_f32 v141, v146, v147
    v_fma_f32 v150, v150, s30, -v217
    v_exp_f32 v150, v150
    v_fma_f32 v151, v151, s30, -v217
    v_exp_f32 v151, v151
    v_add_f32 v216, v216, v148
    v_add_f32 v224, v224, v149
    v_cvt_pk_bf16_f32 v142, v148, v149
    v_fma_f32 v152, v152, s30, -v217
    v_exp_f32 v152, v152
    v_fma_f32 v153, v153, s30, -v217
    v_exp_f32 v153, v153
    v_add_f32 v225, v225, v150
    v_add_f32 v226, v226, v151
    v_cvt_pk_bf16_f32 v143, v150, v151
    v_fma_f32 v154, v154, s30, -v217
    v_exp_f32 v154, v154
    v_fma_f32 v155, v155, s30, -v217
    v_exp_f32 v155, v155
    v_add_f32 v216, v216, v152
    v_add_f32 v224, v224, v153
    v_cvt_pk_bf16_f32 v144, v152, v153
    v_fma_f32 v156, v156, s30, -v217
    v_exp_f32 v156, v156
    v_fma_f32 v157, v157, s30, -v217
    v_exp_f32 v157, v157
    v_add_f32 v225, v225, v154
    v_add_f32 v226, v226, v155
    v_cvt_pk_bf16_f32 v145, v154, v155
    v_fma_f32 v158, v158, s30, -v217
    v_exp_f32 v158, v158
    v_fma_f32 v159, v159, s30, -v217
    v_exp_f32 v159, v159
    v_add_f32 v216, v216, v156
    v_add_f32 v224, v224, v157
    v_cvt_pk_bf16_f32 v146, v156, v157
    v_fma_f32 v160, v160, s30, -v217
    v_exp_f32 v160, v160
    v_fma_f32 v161, v161, s30, -v217
    v_exp_f32 v161, v161
    v_add_f32 v225, v225, v158
    v_add_f32 v226, v226, v159
    v_cvt_pk_bf16_f32 v147, v158, v159
    v_fma_f32 v162, v162, s30, -v217
    v_exp_f32 v162, v162
    v_fma_f32 v163, v163, s30, -v217
    v_exp_f32 v163, v163
    v_add_f32 v216, v216, v160
    v_add_f32 v224, v224, v161
    v_cvt_pk_bf16_f32 v148, v160, v161
    v_fma_f32 v164, v164, s30, -v217
    v_exp_f32 v164, v164
    v_fma_f32 v165, v165, s30, -v217
    v_exp_f32 v165, v165
    v_add_f32 v225, v225, v162
    v_add_f32 v226, v226, v163
    v_cvt_pk_bf16_f32 v149, v162, v163
    v_fma_f32 v166, v166, s30, -v217
    v_exp_f32 v166, v166
    v_fma_f32 v167, v167, s30, -v217
    v_exp_f32 v167, v167
    v_add_f32 v216, v216, v164
    v_add_f32 v224, v224, v165
    v_cvt_pk_bf16_f32 v150, v164, v165
    v_add_f32 v225, v225, v166
    v_add_f32 v226, v226, v167
    v_cvt_pk_bf16_f32 v151, v166, v167
    s_nop 1
attn_kernel_qkdone:
    ds_read_b64_tr_b16 v[184:185], v208 offset:49152
    ds_read_b64_tr_b16 v[186:187], v208 offset:51200
    ds_read_b64_tr_b16 v[188:189], v209 offset:49152
    ds_read_b64_tr_b16 v[190:191], v209 offset:51200
    ds_read_b64_tr_b16 v[192:193], v210 offset:49152
    ds_read_b64_tr_b16 v[194:195], v210 offset:51200
    ds_read_b64_tr_b16 v[196:197], v211 offset:49152
    ds_read_b64_tr_b16 v[198:199], v211 offset:51200
    s_waitcnt lgkmcnt(6)
    v_mfma_f32_32x32x16_bf16 v[40:55], v[184:187], v[136:139], v[40:55]
    ds_read_b64_tr_b16 v[184:185], v208 offset:53248
    ds_read_b64_tr_b16 v[186:187], v208 offset:55296
    s_waitcnt lgkmcnt(6)
    v_mfma_f32_32x32x16_bf16 v[56:71], v[188:191], v[136:139], v[56:71]
    ds_read_b64_tr_b16 v[188:189], v209 offset:53248
    ds_read_b64_tr_b16 v[190:191], v209 offset:55296
    s_waitcnt lgkmcnt(6)
    v_mfma_f32_32x32x16_bf16 v[72:87], v[192:195], v[136:139], v[72:87]
    ds_read_b64_tr_b16 v[192:193], v210 offset:53248
    ds_read_b64_tr_b16 v[194:195], v210 offset:55296
    s_waitcnt lgkmcnt(6)
    v_mfma_f32_32x32x16_bf16 v[88:103], v[196:199], v[136:139], v[88:103]
    ds_read_b64_tr_b16 v[196:197], v211 offset:53248
    ds_read_b64_tr_b16 v[198:199], v211 offset:55296
    s_waitcnt lgkmcnt(6)
    v_mfma_f32_32x32x16_bf16 v[40:55], v[184:187], v[140:143], v[40:55]
    ds_read_b64_tr_b16 v[184:185], v208 offset:57344
    ds_read_b64_tr_b16 v[186:187], v208 offset:59392
    s_waitcnt lgkmcnt(6)
    v_mfma_f32_32x32x16_bf16 v[56:71], v[188:191], v[140:143], v[56:71]
    ds_read_b64_tr_b16 v[188:189], v209 offset:57344
    ds_read_b64_tr_b16 v[190:191], v209 offset:59392
    s_waitcnt lgkmcnt(6)
    v_mfma_f32_32x32x16_bf16 v[72:87], v[192:195], v[140:143], v[72:87]
    ds_read_b64_tr_b16 v[192:193], v210 offset:57344
    ds_read_b64_tr_b16 v[194:195], v210 offset:59392
    s_waitcnt lgkmcnt(6)
    v_mfma_f32_32x32x16_bf16 v[88:103], v[196:199], v[140:143], v[88:103]
    ds_read_b64_tr_b16 v[196:197], v211 offset:57344
    ds_read_b64_tr_b16 v[198:199], v211 offset:59392
    s_waitcnt lgkmcnt(6)
    v_mfma_f32_32x32x16_bf16 v[40:55], v[184:187], v[144:147], v[40:55]
    ds_read_b64_tr_b16 v[184:185], v208 offset:61440
    ds_read_b64_tr_b16 v[186:187], v208 offset:63488
    s_waitcnt lgkmcnt(6)
    v_mfma_f32_32x32x16_bf16 v[56:71], v[188:191], v[144:147], v[56:71]
    ds_read_b64_tr_b16 v[188:189], v209 offset:61440
    ds_read_b64_tr_b16 v[190:191], v209 offset:63488
    s_waitcnt lgkmcnt(6)
    v_mfma_f32_32x32x16_bf16 v[72:87], v[192:195], v[144:147], v[72:87]
    ds_read_b64_tr_b16 v[192:193], v210 offset:61440
    ds_read_b64_tr_b16 v[194:195], v210 offset:63488
    s_waitcnt lgkmcnt(6)
    v_mfma_f32_32x32x16_bf16 v[88:103], v[196:199], v[144:147], v[88:103]
    ds_read_b64_tr_b16 v[196:197], v211 offset:61440
    ds_read_b64_tr_b16 v[198:199], v211 offset:63488
    s_waitcnt lgkmcnt(6)
    v_mfma_f32_32x32x16_bf16 v[40:55], v[184:187], v[148:151], v[40:55]
    s_waitcnt lgkmcnt(4)
    v_mfma_f32_32x32x16_bf16 v[56:71], v[188:191], v[148:151], v[56:71]
    s_waitcnt lgkmcnt(2)
    v_mfma_f32_32x32x16_bf16 v[72:87], v[192:195], v[148:151], v[72:87]
    s_waitcnt lgkmcnt(0)
    v_mfma_f32_32x32x16_bf16 v[88:103], v[196:199], v[148:151], v[88:103]
    s_and_b32 s71, s70, 3
    s_cmp_eq_u32 s71, 3
    s_nop 9
    s_cbranch_scc0 attn_kernel_ne
    s_cmp_eq_u32 s70, 7
    s_cbranch_scc1 attn_kernel_e1
    v_add_f32 v216, v216, v224
    v_add_f32 v225, v225, v226
    v_add_f32 v216, v216, v225
    v_mov_b32 v221, v216
    s_nop 1
    v_permlane32_swap_b32 v216, v221
    v_add_f32 v216, v216, v221
    v_rcp_f32 v220, v216
    s_nop 0
    v_mul_f32 v40, v40, v220
    v_mul_f32 v41, v41, v220
    v_mul_f32 v42, v42, v220
    v_mul_f32 v43, v43, v220
    v_mul_f32 v44, v44, v220
    v_mul_f32 v45, v45, v220
    v_mul_f32 v46, v46, v220
    v_mul_f32 v47, v47, v220
    v_cvt_pk_bf16_f32 v40, v40, v41
    v_cvt_pk_bf16_f32 v41, v42, v43
    v_cvt_pk_bf16_f32 v42, v44, v45
    v_cvt_pk_bf16_f32 v43, v46, v47
    s_nop 0
    v_permlane32_swap_b32 v40, v42
    v_permlane32_swap_b32 v41, v43
    buffer_store_dwordx4 v[40:43], v3, s[24:27], 0 offen offset:0
    v_mul_f32 v48, v48, v220
    v_mul_f32 v49, v49, v220
    v_mul_f32 v50, v50, v220
    v_mul_f32 v51, v51, v220
    v_mul_f32 v52, v52, v220
    v_mul_f32 v53, v53, v220
    v_mul_f32 v54, v54, v220
    v_mul_f32 v55, v55, v220
    v_cvt_pk_bf16_f32 v48, v48, v49
    v_cvt_pk_bf16_f32 v49, v50, v51
    v_cvt_pk_bf16_f32 v50, v52, v53
    v_cvt_pk_bf16_f32 v51, v54, v55
    s_nop 0
    v_permlane32_swap_b32 v48, v50
    v_permlane32_swap_b32 v49, v51
    buffer_store_dwordx4 v[48:51], v3, s[24:27], 0 offen offset:1024
    v_mul_f32 v56, v56, v220
    v_mul_f32 v57, v57, v220
    v_mul_f32 v58, v58, v220
    v_mul_f32 v59, v59, v220
    v_mul_f32 v60, v60, v220
    v_mul_f32 v61, v61, v220
    v_mul_f32 v62, v62, v220
    v_mul_f32 v63, v63, v220
    v_cvt_pk_bf16_f32 v56, v56, v57
    v_cvt_pk_bf16_f32 v57, v58, v59
    v_cvt_pk_bf16_f32 v58, v60, v61
    v_cvt_pk_bf16_f32 v59, v62, v63
    s_nop 0
    v_permlane32_swap_b32 v56, v58
    v_permlane32_swap_b32 v57, v59
    buffer_store_dwordx4 v[56:59], v3, s[24:27], 0 offen offset:2048
    v_mul_f32 v64, v64, v220
    v_mul_f32 v65, v65, v220
    v_mul_f32 v66, v66, v220
    v_mul_f32 v67, v67, v220
    v_mul_f32 v68, v68, v220
    v_mul_f32 v69, v69, v220
    v_mul_f32 v70, v70, v220
    v_mul_f32 v71, v71, v220
    v_cvt_pk_bf16_f32 v64, v64, v65
    v_cvt_pk_bf16_f32 v65, v66, v67
    v_cvt_pk_bf16_f32 v66, v68, v69
    v_cvt_pk_bf16_f32 v67, v70, v71
    s_nop 0
    v_permlane32_swap_b32 v64, v66
    v_permlane32_swap_b32 v65, v67
    buffer_store_dwordx4 v[64:67], v3, s[24:27], 0 offen offset:3072
    v_mul_f32 v72, v72, v220
    v_mul_f32 v73, v73, v220
    v_mul_f32 v74, v74, v220
    v_mul_f32 v75, v75, v220
    v_mul_f32 v76, v76, v220
    v_mul_f32 v77, v77, v220
    v_mul_f32 v78, v78, v220
    v_mul_f32 v79, v79, v220
    v_cvt_pk_bf16_f32 v72, v72, v73
    v_cvt_pk_bf16_f32 v73, v74, v75
    v_cvt_pk_bf16_f32 v74, v76, v77
    v_cvt_pk_bf16_f32 v75, v78, v79
    s_nop 0
    v_permlane32_swap_b32 v72, v74
    v_permlane32_swap_b32 v73, v75
    buffer_store_dwordx4 v[72:75], v4, s[24:27], 0 offen offset:0
    v_mul_f32 v80, v80, v220
    v_mul_f32 v81, v81, v220
    v_mul_f32 v82, v82, v220
    v_mul_f32 v83, v83, v220
    v_mul_f32 v84, v84, v220
    v_mul_f32 v85, v85, v220
    v_mul_f32 v86, v86, v220
    v_mul_f32 v87, v87, v220
    v_cvt_pk_bf16_f32 v80, v80, v81
    v_cvt_pk_bf16_f32 v81, v82, v83
    v_cvt_pk_bf16_f32 v82, v84, v85
    v_cvt_pk_bf16_f32 v83, v86, v87
    s_nop 0
    v_permlane32_swap_b32 v80, v82
    v_permlane32_swap_b32 v81, v83
    buffer_store_dwordx4 v[80:83], v4, s[24:27], 0 offen offset:1024
    v_mul_f32 v88, v88, v220
    v_mul_f32 v89, v89, v220
    v_mul_f32 v90, v90, v220
    v_mul_f32 v91, v91, v220
    v_mul_f32 v92, v92, v220
    v_mul_f32 v93, v93, v220
    v_mul_f32 v94, v94, v220
    v_mul_f32 v95, v95, v220
    v_cvt_pk_bf16_f32 v88, v88, v89
    v_cvt_pk_bf16_f32 v89, v90, v91
    v_cvt_pk_bf16_f32 v90, v92, v93
    v_cvt_pk_bf16_f32 v91, v94, v95
    s_nop 0
    v_permlane32_swap_b32 v88, v90
    v_permlane32_swap_b32 v89, v91
    buffer_store_dwordx4 v[88:91], v4, s[24:27], 0 offen offset:2048
    v_mul_f32 v96, v96, v220
    v_mul_f32 v97, v97, v220
    v_mul_f32 v98, v98, v220
    v_mul_f32 v99, v99, v220
    v_mul_f32 v100, v100, v220
    v_mul_f32 v101, v101, v220
    v_mul_f32 v102, v102, v220
    v_mul_f32 v103, v103, v220
    v_cvt_pk_bf16_f32 v96, v96, v97
    v_cvt_pk_bf16_f32 v97, v98, v99
    v_cvt_pk_bf16_f32 v98, v100, v101
    v_cvt_pk_bf16_f32 v99, v102, v103
    s_nop 0
    v_permlane32_swap_b32 v96, v98
    v_permlane32_swap_b32 v97, v99
    buffer_store_dwordx4 v[96:99], v4, s[24:27], 0 offen offset:3072
    v_mov_b32 v40, 0
    v_mov_b32 v41, 0
    v_mov_b32 v42, 0
    v_mov_b32 v43, 0
    v_mov_b32 v44, 0
    v_mov_b32 v45, 0
    v_mov_b32 v46, 0
    v_mov_b32 v47, 0
    v_mov_b32 v48, 0
    v_mov_b32 v49, 0
    v_mov_b32 v50, 0
    v_mov_b32 v51, 0
    v_mov_b32 v52, 0
    v_mov_b32 v53, 0
    v_mov_b32 v54, 0
    v_mov_b32 v55, 0
    v_mov_b32 v56, 0
    v_mov_b32 v57, 0
    v_mov_b32 v58, 0
    v_mov_b32 v59, 0
    v_mov_b32 v60, 0
    v_mov_b32 v61, 0
    v_mov_b32 v62, 0
    v_mov_b32 v63, 0
    v_mov_b32 v64, 0
    v_mov_b32 v65, 0
    v_mov_b32 v66, 0
    v_mov_b32 v67, 0
    v_mov_b32 v68, 0
    v_mov_b32 v69, 0
    v_mov_b32 v70, 0
    v_mov_b32 v71, 0
    v_mov_b32 v72, 0
    v_mov_b32 v73, 0
    v_mov_b32 v74, 0
    v_mov_b32 v75, 0
    v_mov_b32 v76, 0
    v_mov_b32 v77, 0
    v_mov_b32 v78, 0
    v_mov_b32 v79, 0
    v_mov_b32 v80, 0
    v_mov_b32 v81, 0
    v_mov_b32 v82, 0
    v_mov_b32 v83, 0
    v_mov_b32 v84, 0
    v_mov_b32 v85, 0
    v_mov_b32 v86, 0
    v_mov_b32 v87, 0
    v_mov_b32 v88, 0
    v_mov_b32 v89, 0
    v_mov_b32 v90, 0
    v_mov_b32 v91, 0
    v_mov_b32 v92, 0
    v_mov_b32 v93, 0
    v_mov_b32 v94, 0
    v_mov_b32 v95, 0
    v_mov_b32 v96, 0
    v_mov_b32 v97, 0
    v_mov_b32 v98, 0
    v_mov_b32 v99, 0
    v_mov_b32 v100, 0
    v_mov_b32 v101, 0
    v_mov_b32 v102, 0
    v_mov_b32 v103, 0
    v_mov_b32 v215, 0xf149f2ca
    v_mov_b32 v218, 0xf149f2ca
    v_mov_b32 v217, 0
    v_mov_b32 v216, 0
    v_mov_b32 v224, 0
    v_mov_b32 v225, 0
    v_mov_b32 v226, 0
    s_nop 1
    s_branch attn_kernel_ne
attn_kernel_e1:
    v_add_f32 v216, v216, v224
    v_add_f32 v225, v225, v226
    v_add_f32 v216, v216, v225
    v_mov_b32 v221, v216
    s_nop 1
    v_permlane32_swap_b32 v216, v221
    v_add_f32 v216, v216, v221
    v_rcp_f32 v220, v216
    s_nop 0
    v_mul_f32 v40, v40, v220
    v_mul_f32 v41, v41, v220
    v_mul_f32 v42, v42, v220
    v_mul_f32 v43, v43, v220
    v_mul_f32 v44, v44, v220
    v_mul_f32 v45, v45, v220
    v_mul_f32 v46, v46, v220
    v_mul_f32 v47, v47, v220
    v_cvt_pk_bf16_f32 v40, v40, v41
    v_cvt_pk_bf16_f32 v41, v42, v43
    v_cvt_pk_bf16_f32 v42, v44, v45
    v_cvt_pk_bf16_f32 v43, v46, v47
    s_nop 0
    v_permlane32_swap_b32 v40, v42
    v_permlane32_swap_b32 v41, v43
    buffer_store_dwordx4 v[40:43], v3, s[56:59], 0 offen offset:0
    v_mul_f32 v48, v48, v220
    v_mul_f32 v49, v49, v220
    v_mul_f32 v50, v50, v220
    v_mul_f32 v51, v51, v220
    v_mul_f32 v52, v52, v220
    v_mul_f32 v53, v53, v220
    v_mul_f32 v54, v54, v220
    v_mul_f32 v55, v55, v220
    v_cvt_pk_bf16_f32 v48, v48, v49
    v_cvt_pk_bf16_f32 v49, v50, v51
    v_cvt_pk_bf16_f32 v50, v52, v53
    v_cvt_pk_bf16_f32 v51, v54, v55
    s_nop 0
    v_permlane32_swap_b32 v48, v50
    v_permlane32_swap_b32 v49, v51
    buffer_store_dwordx4 v[48:51], v3, s[56:59], 0 offen offset:1024
    v_mul_f32 v56, v56, v220
    v_mul_f32 v57, v57, v220
    v_mul_f32 v58, v58, v220
    v_mul_f32 v59, v59, v220
    v_mul_f32 v60, v60, v220
    v_mul_f32 v61, v61, v220
    v_mul_f32 v62, v62, v220
    v_mul_f32 v63, v63, v220
    v_cvt_pk_bf16_f32 v56, v56, v57
    v_cvt_pk_bf16_f32 v57, v58, v59
    v_cvt_pk_bf16_f32 v58, v60, v61
    v_cvt_pk_bf16_f32 v59, v62, v63
    s_nop 0
    v_permlane32_swap_b32 v56, v58
    v_permlane32_swap_b32 v57, v59
    buffer_store_dwordx4 v[56:59], v3, s[56:59], 0 offen offset:2048
    v_mul_f32 v64, v64, v220
    v_mul_f32 v65, v65, v220
    v_mul_f32 v66, v66, v220
    v_mul_f32 v67, v67, v220
    v_mul_f32 v68, v68, v220
    v_mul_f32 v69, v69, v220
    v_mul_f32 v70, v70, v220
    v_mul_f32 v71, v71, v220
    v_cvt_pk_bf16_f32 v64, v64, v65
    v_cvt_pk_bf16_f32 v65, v66, v67
    v_cvt_pk_bf16_f32 v66, v68, v69
    v_cvt_pk_bf16_f32 v67, v70, v71
    s_nop 0
    v_permlane32_swap_b32 v64, v66
    v_permlane32_swap_b32 v65, v67
    buffer_store_dwordx4 v[64:67], v3, s[56:59], 0 offen offset:3072
    v_mul_f32 v72, v72, v220
    v_mul_f32 v73, v73, v220
    v_mul_f32 v74, v74, v220
    v_mul_f32 v75, v75, v220
    v_mul_f32 v76, v76, v220
    v_mul_f32 v77, v77, v220
    v_mul_f32 v78, v78, v220
    v_mul_f32 v79, v79, v220
    v_cvt_pk_bf16_f32 v72, v72, v73
    v_cvt_pk_bf16_f32 v73, v74, v75
    v_cvt_pk_bf16_f32 v74, v76, v77
    v_cvt_pk_bf16_f32 v75, v78, v79
    s_nop 0
    v_permlane32_swap_b32 v72, v74
    v_permlane32_swap_b32 v73, v75
    buffer_store_dwordx4 v[72:75], v4, s[56:59], 0 offen offset:0
    v_mul_f32 v80, v80, v220
    v_mul_f32 v81, v81, v220
    v_mul_f32 v82, v82, v220
    v_mul_f32 v83, v83, v220
    v_mul_f32 v84, v84, v220
    v_mul_f32 v85, v85, v220
    v_mul_f32 v86, v86, v220
    v_mul_f32 v87, v87, v220
    v_cvt_pk_bf16_f32 v80, v80, v81
    v_cvt_pk_bf16_f32 v81, v82, v83
    v_cvt_pk_bf16_f32 v82, v84, v85
    v_cvt_pk_bf16_f32 v83, v86, v87
    s_nop 0
    v_permlane32_swap_b32 v80, v82
    v_permlane32_swap_b32 v81, v83
    buffer_store_dwordx4 v[80:83], v4, s[56:59], 0 offen offset:1024
    v_mul_f32 v88, v88, v220
    v_mul_f32 v89, v89, v220
    v_mul_f32 v90, v90, v220
    v_mul_f32 v91, v91, v220
    v_mul_f32 v92, v92, v220
    v_mul_f32 v93, v93, v220
    v_mul_f32 v94, v94, v220
    v_mul_f32 v95, v95, v220
    v_cvt_pk_bf16_f32 v88, v88, v89
    v_cvt_pk_bf16_f32 v89, v90, v91
    v_cvt_pk_bf16_f32 v90, v92, v93
    v_cvt_pk_bf16_f32 v91, v94, v95
    s_nop 0
    v_permlane32_swap_b32 v88, v90
    v_permlane32_swap_b32 v89, v91
    buffer_store_dwordx4 v[88:91], v4, s[56:59], 0 offen offset:2048
    v_mul_f32 v96, v96, v220
    v_mul_f32 v97, v97, v220
    v_mul_f32 v98, v98, v220
    v_mul_f32 v99, v99, v220
    v_mul_f32 v100, v100, v220
    v_mul_f32 v101, v101, v220
    v_mul_f32 v102, v102, v220
    v_mul_f32 v103, v103, v220
    v_cvt_pk_bf16_f32 v96, v96, v97
    v_cvt_pk_bf16_f32 v97, v98, v99
    v_cvt_pk_bf16_f32 v98, v100, v101
    v_cvt_pk_bf16_f32 v99, v102, v103
    s_nop 0
    v_permlane32_swap_b32 v96, v98
    v_permlane32_swap_b32 v97, v99
    buffer_store_dwordx4 v[96:99], v4, s[56:59], 0 offen offset:3072
    s_nop 0
attn_kernel_ne:
    s_add_u32 s70, s70, 1
    s_cmp_lt_u32 s70, 8
    s_cbranch_scc1 attn_kernel_loop
    s_waitcnt vmcnt(0)
    s_branch attn_kernel_exit
attn_kernel_slow1:
    v_mov_b32 v221, v220
    s_nop 1
    v_permlane32_swap_b32 v220, v221
    v_max_f32 v220, v220, v221
    v_max_f32 v220, v220, v215
    v_sub_f32 v221, v215, v220
    v_mul_f32 v221, s30, v221
    v_exp_f32 v219, v221
    v_mov_b32 v215, v220
    v_mul_f32 v217, s30, v220
    v_add_f32 v218, 0x427af233, v220
    v_mul_f32 v216, v216, v219
    v_mul_f32 v224, v224, v219
    v_mul_f32 v225, v225, v219
    v_mul_f32 v226, v226, v219
    v_mul_f32 v40, v40, v219
    v_mul_f32 v41, v41, v219
    v_mul_f32 v42, v42, v219
    v_mul_f32 v43, v43, v219
    v_mul_f32 v44, v44, v219
    v_mul_f32 v45, v45, v219
    v_mul_f32 v46, v46, v219
    v_mul_f32 v47, v47, v219
    v_mul_f32 v48, v48, v219
    v_mul_f32 v49, v49, v219
    v_mul_f32 v50, v50, v219
    v_mul_f32 v51, v51, v219
    v_mul_f32 v52, v52, v219
    v_mul_f32 v53, v53, v219
    v_mul_f32 v54, v54, v219
    v_mul_f32 v55, v55, v219
    v_mul_f32 v56, v56, v219
    v_mul_f32 v57, v57, v219
    v_mul_f32 v58, v58, v219
    v_mul_f32 v59, v59, v219
    v_mul_f32 v60, v60, v219
    v_mul_f32 v61, v61, v219
    v_mul_f32 v62, v62, v219
    v_mul_f32 v63, v63, v219
    v_mul_f32 v64, v64, v219
    v_mul_f32 v65, v65, v219
    v_mul_f32 v66, v66, v219
    v_mul_f32 v67, v67, v219
    v_mul_f32 v68, v68, v219
    v_mul_f32 v69, v69, v219
    v_mul_f32 v70, v70, v219
    v_mul_f32 v71, v71, v219
    v_mul_f32 v72, v72, v219
    v_mul_f32 v73, v73, v219
    v_mul_f32 v74, v74, v219
    v_mul_f32 v75, v75, v219
    v_mul_f32 v76, v76, v219
    v_mul_f32 v77, v77, v219
    v_mul_f32 v78, v78, v219
    v_mul_f32 v79, v79, v219
    v_mul_f32 v80, v80, v219
    v_mul_f32 v81, v81, v219
    v_mul_f32 v82, v82, v219
    v_mul_f32 v83, v83, v219
    v_mul_f32 v84, v84, v219
    v_mul_f32 v85, v85, v219
    v_mul_f32 v86, v86, v219
    v_mul_f32 v87, v87, v219
    v_mul_f32 v88, v88, v219
    v_mul_f32 v89, v89, v219
    v_mul_f32 v90, v90, v219
    v_mul_f32 v91, v91, v219
    v_mul_f32 v92, v92, v219
    v_mul_f32 v93, v93, v219
    v_mul_f32 v94, v94, v219
    v_mul_f32 v95, v95, v219
    v_mul_f32 v96, v96, v219
    v_mul_f32 v97, v97, v219
    v_mul_f32 v98, v98, v219
    v_mul_f32 v99, v99, v219
    v_mul_f32 v100, v100, v219
    v_mul_f32 v101, v101, v219
    v_mul_f32 v102, v102, v219
    v_mul_f32 v103, v103, v219
    s_nop 1
    s_branch attn_kernel_back1
attn_kernel_slow2:
    v_mov_b32 v221, v220
    s_nop 1
    v_permlane32_swap_b32 v220, v221
    v_max_f32 v220, v220, v221
    v_max_f32 v220, v220, v215
    v_sub_f32 v221, v215, v220
    v_mul_f32 v221, s30, v221
    v_exp_f32 v219, v221
    v_mov_b32 v215, v220
    v_mul_f32 v217, s30, v220
    v_add_f32 v218, 0x427af233, v220
    v_mul_f32 v216, v216, v219
    v_mul_f32 v224, v224, v219
    v_mul_f32 v225, v225, v219
    v_mul_f32 v226, v226, v219
    v_mul_f32 v40, v40, v219
    v_mul_f32 v41, v41, v219
    v_mul_f32 v42, v42, v219
    v_mul_f32 v43, v43, v219
    v_mul_f32 v44, v44, v219
    v_mul_f32 v45, v45, v219
    v_mul_f32 v46, v46, v219
    v_mul_f32 v47, v47, v219
    v_mul_f32 v48, v48, v219
    v_mul_f32 v49, v49, v219
    v_mul_f32 v50, v50, v219
    v_mul_f32 v51, v51, v219
    v_mul_f32 v52, v52, v219
    v_mul_f32 v53, v53, v219
    v_mul_f32 v54, v54, v219
    v_mul_f32 v55, v55, v219
    v_mul_f32 v56, v56, v219
    v_mul_f32 v57, v57, v219
    v_mul_f32 v58, v58, v219
    v_mul_f32 v59, v59, v219
    v_mul_f32 v60, v60, v219
    v_mul_f32 v61, v61, v219
    v_mul_f32 v62, v62, v219
    v_mul_f32 v63, v63, v219
    v_mul_f32 v64, v64, v219
    v_mul_f32 v65, v65, v219
    v_mul_f32 v66, v66, v219
    v_mul_f32 v67, v67, v219
    v_mul_f32 v68, v68, v219
    v_mul_f32 v69, v69, v219
    v_mul_f32 v70, v70, v219
    v_mul_f32 v71, v71, v219
    v_mul_f32 v72, v72, v219
    v_mul_f32 v73, v73, v219
    v_mul_f32 v74, v74, v219
    v_mul_f32 v75, v75, v219
    v_mul_f32 v76, v76, v219
    v_mul_f32 v77, v77, v219
    v_mul_f32 v78, v78, v219
    v_mul_f32 v79, v79, v219
    v_mul_f32 v80, v80, v219
    v_mul_f32 v81, v81, v219
    v_mul_f32 v82, v82, v219
    v_mul_f32 v83, v83, v219
    v_mul_f32 v84, v84, v219
    v_mul_f32 v85, v85, v219
    v_mul_f32 v86, v86, v219
    v_mul_f32 v87, v87, v219
    v_mul_f32 v88, v88, v219
    v_mul_f32 v89, v89, v219
    v_mul_f32 v90, v90, v219
    v_mul_f32 v91, v91, v219
    v_mul_f32 v92, v92, v219
    v_mul_f32 v93, v93, v219
    v_mul_f32 v94, v94, v219
    v_mul_f32 v95, v95, v219
    v_mul_f32 v96, v96, v219
    v_mul_f32 v97, v97, v219
    v_mul_f32 v98, v98, v219
    v_mul_f32 v99, v99, v219
    v_mul_f32 v100, v100, v219
    v_mul_f32 v101, v101, v219
    v_mul_f32 v102, v102, v219
    v_mul_f32 v103, v103, v219
    s_nop 1
    s_branch attn_kernel_back2
attn_kernel_slow3:
    v_mov_b32 v221, v220
    s_nop 1
    v_permlane32_swap_b32 v220, v221
    v_max_f32 v220, v220, v221
    v_max_f32 v220, v220, v215
    v_sub_f32 v221, v215, v220
    v_mul_f32 v221, s30, v221
    v_exp_f32 v219, v221
    v_mov_b32 v215, v220
    v_mul_f32 v217, s30, v220
    v_add_f32 v218, 0x427af233, v220
    v_mul_f32 v216, v216, v219
    v_mul_f32 v224, v224, v219
    v_mul_f32 v225, v225, v219
    v_mul_f32 v226, v226, v219
    v_mul_f32 v40, v40, v219
    v_mul_f32 v41, v41, v219
    v_mul_f32 v42, v42, v219
    v_mul_f32 v43, v43, v219
    v_mul_f32 v44, v44, v219
    v_mul_f32 v45, v45, v219
    v_mul_f32 v46, v46, v219
    v_mul_f32 v47, v47, v219
    v_mul_f32 v48, v48, v219
    v_mul_f32 v49, v49, v219
    v_mul_f32 v50, v50, v219
    v_mul_f32 v51, v51, v219
    v_mul_f32 v52, v52, v219
    v_mul_f32 v53, v53, v219
    v_mul_f32 v54, v54, v219
    v_mul_f32 v55, v55, v219
    v_mul_f32 v56, v56, v219
    v_mul_f32 v57, v57, v219
    v_mul_f32 v58, v58, v219
    v_mul_f32 v59, v59, v219
    v_mul_f32 v60, v60, v219
    v_mul_f32 v61, v61, v219
    v_mul_f32 v62, v62, v219
    v_mul_f32 v63, v63, v219
    v_mul_f32 v64, v64, v219
    v_mul_f32 v65, v65, v219
    v_mul_f32 v66, v66, v219
    v_mul_f32 v67, v67, v219
    v_mul_f32 v68, v68, v219
    v_mul_f32 v69, v69, v219
    v_mul_f32 v70, v70, v219
    v_mul_f32 v71, v71, v219
    v_mul_f32 v72, v72, v219
    v_mul_f32 v73, v73, v219
    v_mul_f32 v74, v74, v219
    v_mul_f32 v75, v75, v219
    v_mul_f32 v76, v76, v219
    v_mul_f32 v77, v77, v219
    v_mul_f32 v78, v78, v219
    v_mul_f32 v79, v79, v219
    v_mul_f32 v80, v80, v219
    v_mul_f32 v81, v81, v219
    v_mul_f32 v82, v82, v219
    v_mul_f32 v83, v83, v219
    v_mul_f32 v84, v84, v219
    v_mul_f32 v85, v85, v219
    v_mul_f32 v86, v86, v219
    v_mul_f32 v87, v87, v219
    v_mul_f32 v88, v88, v219
    v_mul_f32 v89, v89, v219
    v_mul_f32 v90, v90, v219
    v_mul_f32 v91, v91, v219
    v_mul_f32 v92, v92, v219
    v_mul_f32 v93, v93, v219
    v_mul_f32 v94, v94, v219
    v_mul_f32 v95, v95, v219
    v_mul_f32 v96, v96, v219
    v_mul_f32 v97, v97, v219
    v_mul_f32 v98, v98, v219
    v_mul_f32 v99, v99, v219
    v_mul_f32 v100, v100, v219
    v_mul_f32 v101, v101, v219
    v_mul_f32 v102, v102, v219
    v_mul_f32 v103, v103, v219
    s_nop 1
    s_branch attn_kernel_back3
attn_kernel_slow4:
    v_mov_b32 v221, v220
    s_nop 1
    v_permlane32_swap_b32 v220, v221
    v_max_f32 v220, v220, v221
    v_max_f32 v220, v220, v215
    v_sub_f32 v221, v215, v220
    v_mul_f32 v221, s30, v221
    v_exp_f32 v219, v221
    v_mov_b32 v215, v220
    v_mul_f32 v217, s30, v220
    v_add_f32 v218, 0x427af233, v220
    v_mul_f32 v216, v216, v219
    v_mul_f32 v224, v224, v219
    v_mul_f32 v225, v225, v219
    v_mul_f32 v226, v226, v219
    v_mul_f32 v40, v40, v219
    v_mul_f32 v41, v41, v219
    v_mul_f32 v42, v42, v219
    v_mul_f32 v43, v43, v219
    v_mul_f32 v44, v44, v219
    v_mul_f32 v45, v45, v219
    v_mul_f32 v46, v46, v219
    v_mul_f32 v47, v47, v219
    v_mul_f32 v48, v48, v219
    v_mul_f32 v49, v49, v219
    v_mul_f32 v50, v50, v219
    v_mul_f32 v51, v51, v219
    v_mul_f32 v52, v52, v219
    v_mul_f32 v53, v53, v219
    v_mul_f32 v54, v54, v219
    v_mul_f32 v55, v55, v219
    v_mul_f32 v56, v56, v219
    v_mul_f32 v57, v57, v219
    v_mul_f32 v58, v58, v219
    v_mul_f32 v59, v59, v219
    v_mul_f32 v60, v60, v219
    v_mul_f32 v61, v61, v219
    v_mul_f32 v62, v62, v219
    v_mul_f32 v63, v63, v219
    v_mul_f32 v64, v64, v219
    v_mul_f32 v65, v65, v219
    v_mul_f32 v66, v66, v219
    v_mul_f32 v67, v67, v219
    v_mul_f32 v68, v68, v219
    v_mul_f32 v69, v69, v219
    v_mul_f32 v70, v70, v219
    v_mul_f32 v71, v71, v219
    v_mul_f32 v72, v72, v219
    v_mul_f32 v73, v73, v219
    v_mul_f32 v74, v74, v219
    v_mul_f32 v75, v75, v219
    v_mul_f32 v76, v76, v219
    v_mul_f32 v77, v77, v219
    v_mul_f32 v78, v78, v219
    v_mul_f32 v79, v79, v219
    v_mul_f32 v80, v80, v219
    v_mul_f32 v81, v81, v219
    v_mul_f32 v82, v82, v219
    v_mul_f32 v83, v83, v219
    v_mul_f32 v84, v84, v219
    v_mul_f32 v85, v85, v219
    v_mul_f32 v86, v86, v219
    v_mul_f32 v87, v87, v219
    v_mul_f32 v88, v88, v219
    v_mul_f32 v89, v89, v219
    v_mul_f32 v90, v90, v219
    v_mul_f32 v91, v91, v219
    v_mul_f32 v92, v92, v219
    v_mul_f32 v93, v93, v219
    v_mul_f32 v94, v94, v219
    v_mul_f32 v95, v95, v219
    v_mul_f32 v96, v96, v219
    v_mul_f32 v97, v97, v219
    v_mul_f32 v98, v98, v219
    v_mul_f32 v99, v99, v219
    v_mul_f32 v100, v100, v219
    v_mul_f32 v101, v101, v219
    v_mul_f32 v102, v102, v219
    v_mul_f32 v103, v103, v219
    s_nop 1
    s_branch attn_kernel_back4
attn_kernel_slow4b:
    v_mov_b32 v221, v220
    s_nop 1
    v_permlane32_swap_b32 v220, v221
    v_max_f32 v220, v220, v221
    v_max_f32 v220, v220, v215
    v_sub_f32 v221, v215, v220
    v_mul_f32 v221, s30, v221
    v_exp_f32 v219, v221
    v_mov_b32 v215, v220
    v_mul_f32 v217, s30, v220
    v_add_f32 v218, 0x427af233, v220
    v_mul_f32 v216, v216, v219
    v_mul_f32 v224, v224, v219
    v_mul_f32 v225, v225, v219
    v_mul_f32 v226, v226, v219
    v_mul_f32 v40, v40, v219
    v_mul_f32 v41, v41, v219
    v_mul_f32 v42, v42, v219
    v_mul_f32 v43, v43, v219
    v_mul_f32 v44, v44, v219
    v_mul_f32 v45, v45, v219
    v_mul_f32 v46, v46, v219
    v_mul_f32 v47, v47, v219
    v_mul_f32 v48, v48, v219
    v_mul_f32 v49, v49, v219
    v_mul_f32 v50, v50, v219
    v_mul_f32 v51, v51, v219
    v_mul_f32 v52, v52, v219
    v_mul_f32 v53, v53, v219
    v_mul_f32 v54, v54, v219
    v_mul_f32 v55, v55, v219
    v_mul_f32 v56, v56, v219
    v_mul_f32 v57, v57, v219
    v_mul_f32 v58, v58, v219
    v_mul_f32 v59, v59, v219
    v_mul_f32 v60, v60, v219
    v_mul_f32 v61, v61, v219
    v_mul_f32 v62, v62, v219
    v_mul_f32 v63, v63, v219
    v_mul_f32 v64, v64, v219
    v_mul_f32 v65, v65, v219
    v_mul_f32 v66, v66, v219
    v_mul_f32 v67, v67, v219
    v_mul_f32 v68, v68, v219
    v_mul_f32 v69, v69, v219
    v_mul_f32 v70, v70, v219
    v_mul_f32 v71, v71, v219
    v_mul_f32 v72, v72, v219
    v_mul_f32 v73, v73, v219
    v_mul_f32 v74, v74, v219
    v_mul_f32 v75, v75, v219
    v_mul_f32 v76, v76, v219
    v_mul_f32 v77, v77, v219
    v_mul_f32 v78, v78, v219
    v_mul_f32 v79, v79, v219
    v_mul_f32 v80, v80, v219
    v_mul_f32 v81, v81, v219
    v_mul_f32 v82, v82, v219
    v_mul_f32 v83, v83, v219
    v_mul_f32 v84, v84, v219
    v_mul_f32 v85, v85, v219
    v_mul_f32 v86, v86, v219
    v_mul_f32 v87, v87, v219
    v_mul_f32 v88, v88, v219
    v_mul_f32 v89, v89, v219
    v_mul_f32 v90, v90, v219
    v_mul_f32 v91, v91, v219
    v_mul_f32 v92, v92, v219
    v_mul_f32 v93, v93, v219
    v_mul_f32 v94, v94, v219
    v_mul_f32 v95, v95, v219
    v_mul_f32 v96, v96, v219
    v_mul_f32 v97, v97, v219
    v_mul_f32 v98, v98, v219
    v_mul_f32 v99, v99, v219
    v_mul_f32 v100, v100, v219
    v_mul_f32 v101, v101, v219
    v_mul_f32 v102, v102, v219
    v_mul_f32 v103, v103, v219
    s_nop 1
    s_branch attn_kernel_back4b
attn_kernel_exit:
    s_endpgm
.globl gemm3_kernel
.p2align 8
.type gemm3_kernel,@function
gemm3_kernel:
    s_cmp_ge_u32 s2, 256
    s_cbranch_scc1 gemm3_kernel_exit
    s_lshr_b32 s33, s2, 7
    s_lshr_b32 s34, s2, 4
    s_and_b32 s34, s34, 7
    s_lshr_b32 s35, s2, 2
    s_and_b32 s35, s35, 3
    s_and_b32 s38, s2, 3
    s_load_dwordx2 s[6:7], s[0:1], 32
    s_load_dwordx2 s[40:41], s[0:1], 72
    s_waitcnt lgkmcnt(0)
    s_cmp_lg_u32 s33, 0
    s_cselect_b32 s6, s40, s6
    s_cselect_b32 s7, s41, s7
    s_load_dwordx2 s[8:9], s[0:1], 96
    s_waitcnt lgkmcnt(0)
    s_lshl_b32 s36, s33, 3
    s_add_u32 s36, s36, s34
    s_lshl_b32 s37, s36, 21
    s_add_u32 s37, s37, 33554432
    s_lshl_b32 s39, s38, 19
    s_add_u32 s37, s37, s39
    s_add_u32 s12, s8, s37
    s_addc_u32 s13, s9, 0
    s_mov_b32 s14, 524288
    s_mov_b32 s15, 0x00020000
    s_mul_i32 s37, s38, 1310720
    s_mul_i32 s39, s35, 320
    s_add_u32 s37, s37, s39
    s_add_u32 s16, s6, s37
    s_addc_u32 s17, s7, 0
    s_mov_b32 s18, 1309760
    s_mov_b32 s19, 0x00020000
    s_lshl_b32 s37, s38, 4
    s_add_u32 s37, s37, s36
    s_mul_i32 s37, s37, 655360
    s_add_u32 s37, s37, 67108864
    s_mul_i32 s39, s35, 20480
    s_add_u32 s37, s37, s39
    s_add_u32 s20, s8, s37
    s_addc_u32 s21, s9, 0
    s_mov_b32 s22, 593920
    s_mov_b32 s23, 0x00020000
    v_and_b32 v1, 63, v0
    v_lshrrev_b32 v2, 6, v0
    s_nop 0
    v_readfirstlane_b32 s24, v2
    s_lshr_b32 s25, s24, 0
    s_and_b32 s26, s24, 0
    v_lshlrev_b32 v170, 4, v1
    s_lshl_b32 s27, s24, 13
    v_add_u32 v170, s27, v170
    v_add_u32 v162, 0, v170
    v_lshlrev_b32 v170, 4, v1
    s_lshl_b32 s27, s24, 13
    v_add_u32 v170, s27, v170
    v_add_u32 v163, 1024, v170
    v_lshlrev_b32 v170, 4, v1
    s_lshl_b32 s27, s24, 13
    v_add_u32 v170, s27, v170
    v_add_u32 v164, 2048, v170
    v_lshlrev_b32 v170, 4, v1
    s_lshl_b32 s27, s24, 13
    v_add_u32 v170, s27, v170
    v_add_u32 v165, 3072, v170
    s_mul_i32 s27, s24, 3072
    v_lshlrev_b32 v170, 4, v1
    v_add_u32 v170, s27, v170
    v_add_u32 v170, 0, v170
    s_mov_b32 s27, 52429
    v_mul_lo_u32 v171, v170, s27
    v_lshrrev_b32 v171, 24, v171
    s_movk_i32 s27, 320
    v_mul_lo_u32 v172, v171, s27
    v_sub_u32 v172, v170, v172
    v_min_u32 v171, 63, v171
    s_movk_i32 s27, 1280
    v_mul_lo_u32 v171, v171, s27
    v_add_u32 v166, v171, v172
    s_mul_i32 s27, s24, 3072
    v_lshlrev_b32 v170, 4, v1
    v_add_u32 v170, s27, v170
    v_add_u32 v170, 1024, v170
    s_mov_b32 s27, 52429
    v_mul_lo_u32 v171, v170, s27
    v_lshrrev_b32 v171, 24, v171
    s_movk_i32 s27, 320
    v_mul_lo_u32 v172, v171, s27
    v_sub_u32 v172, v170, v172
    v_min_u32 v171, 63, v171
    s_movk_i32 s27, 1280
    v_mul_lo_u32 v171, v171, s27
    v_add_u32 v167, v171, v172
    s_mul_i32 s27, s24, 3072
    v_lshlrev_b32 v170, 4, v1
    v_add_u32 v170, s27, v170
    v_add_u32 v170, 2048, v170
    s_mov_b32 s27, 52429
    v_mul_lo_u32 v171, v170, s27
    v_lshrrev_b32 v171, 24, v171
    s_movk_i32 s27, 320
    v_mul_lo_u32 v172, v171, s27
    v_sub_u32 v172, v170, v172
    v_min_u32 v171, 63, v171
    s_movk_i32 s27, 1280
    v_mul_lo_u32 v171, v171, s27
    v_add_u32 v168, v171, v172
    v_and_b32 v170, 31, v1
    s_mul_i32 s27, s25, 32
    v_add_u32 v170, s27, v170
    v_lshrrev_b32 v171, 1, v170
    v_and_b32 v171, 7, v171
    v_lshrrev_b32 v172, 5, v1
    v_xor_b32 v171, v171, v172
    v_lshlrev_b32 v170, 7, v170
    v_xor_b32 v172, 0, v171
    v_lshlrev_b32 v172, 4, v172
    v_add_u32 v144, v170, v172
    v_lshlrev_b32 v172, 4, v1
    s_lshl_b32 s27, s24, 12
    v_add_u32 v172, s27, v172
    v_add_u32 v144, 0, v172
    v_add_u32 v148, 57344, v144
    v_xor_b32 v172, 2, v171
    v_lshlrev_b32 v172, 4, v172
    v_add_u32 v145, v170, v172
    v_lshlrev_b32 v172, 4, v1
    s_lshl_b32 s27, s24, 12
    v_add_u32 v172, s27, v172
    v_add_u32 v145, 1024, v172
    v_add_u32 v149, 57344, v145
    v_xor_b32 v172, 4, v171
    v_lshlrev_b32 v172, 4, v172
    v_add_u32 v146, v170, v172
    v_lshlrev_b32 v172, 4, v1
    s_lshl_b32 s27, s24, 12
    v_add_u32 v172, s27, v172
    v_add_u32 v146, 2048, v172
    v_add_u32 v150, 57344, v146
    v_xor_b32 v172, 6, v171
    v_lshlrev_b32 v172, 4, v172
    v_add_u32 v147, v170, v172
    v_lshlrev_b32 v172, 4, v1
    s_lshl_b32 s27, s24, 12
    v_add_u32 v172, s27, v172
    v_add_u32 v147, 3072, v172
    v_add_u32 v151, 57344, v147
    v_lshrrev_b32 v170, 2, v1
    v_and_b32 v170, 3, v170
    v_lshrrev_b32 v171, 5, v1
    v_lshlrev_b32 v171, 3, v171
    v_add_u32 v171, v171, v170
    s_movk_i32 s27, 320
    v_mul_lo_u32 v171, v171, s27
    v_add_u32 v171, 32768, v171
    v_lshrrev_b32 v172, 4, v1
    v_and_b32 v172, 1, v172
    v_lshlrev_b32 v172, 5, v172
    v_add_u32 v171, v171, v172
    v_and_b32 v172, 3, v1
    v_lshlrev_b32 v172, 3, v172
    v_add_u32 v171, v171, v172
    s_mul_i32 s27, s26, 5
    s_add_u32 s28, s27, 0
    v_mov_b32 v172, s28
    v_lshlrev_b32 v172, 6, v172
    v_add_u32 v152, v171, v172
    v_add_u32 v157, 57344, v152
    s_add_u32 s28, s27, 1
    v_mov_b32 v172, s28
    v_lshlrev_b32 v172, 6, v172
    v_add_u32 v153, v171, v172
    v_add_u32 v158, 57344, v153
    s_add_u32 s28, s27, 2
    v_mov_b32 v172, s28
    v_lshlrev_b32 v172, 6, v172
    v_add_u32 v154, v171, v172
    v_add_u32 v159, 57344, v154
    s_add_u32 s28, s27, 3
    v_mov_b32 v172, s28
    v_lshlrev_b32 v172, 6, v172
    v_add_u32 v155, v171, v172
    v_add_u32 v160, 57344, v155
    s_add_u32 s28, s27, 4
    v_mov_b32 v172, s28
    v_lshlrev_b32 v172, 6, v172
    v_add_u32 v156, v171, v172
    v_add_u32 v161, 57344, v156
    v_and_b32 v170, 31, v1
    s_mul_i32 s27, s25, 32
    s_add_u32 s27, s27, 0
    v_add_u32 v170, s27, v170
    s_mov_b32 s27, 2560
    v_mul_lo_u32 v171, v170, s27
    v_cmp_gt_u32 vcc, 240, v170
    v_mov_b32 v172, 0x80000000
    s_nop 0
    v_cndmask_b32 v169, v172, v171, vcc
    v_mov_b32 v16, 0
    v_mov_b32 v17, 0
    v_mov_b32 v18, 0
    v_mov_b32 v19, 0
    v_mov_b32 v20, 0
    v_mov_b32 v21, 0
    v_mov_b32 v22, 0
    v_mov_b32 v23, 0
    v_mov_b32 v24, 0
    v_mov_b32 v25, 0
    v_mov_b32 v26, 0
    v_mov_b32 v27, 0
    v_mov_b32 v28, 0
    v_mov_b32 v29, 0
    v_mov_b32 v30, 0
    v_mov_b32 v31, 0
    v_mov_b32 v32, 0
    v_mov_b32 v33, 0
    v_mov_b32 v34, 0
    v_mov_b32 v35, 0
    v_mov_b32 v36, 0
    v_mov_b32 v37, 0
    v_mov_b32 v38, 0
    v_mov_b32 v39, 0
    v_mov_b32 v40, 0
    v_mov_b32 v41, 0
    v_mov_b32 v42, 0
    v_mov_b32 v43, 0
    v_mov_b32 v44, 0
    v_mov_b32 v45, 0
    v_mov_b32 v46, 0
    v_mov_b32 v47, 0
    v_mov_b32 v48, 0
    v_mov_b32 v49, 0
    v_mov_b32 v50, 0
    v_mov_b32 v51, 0
    v_mov_b32 v52, 0
    v_mov_b32 v53, 0
    v_mov_b32 v54, 0
    v_mov_b32 v55, 0
    v_mov_b32 v56, 0
    v_mov_b32 v57, 0
    v_mov_b32 v58, 0
    v_mov_b32 v59, 0
    v_mov_b32 v60, 0
    v_mov_b32 v61, 0
    v_mov_b32 v62, 0
    v_mov_b32 v63, 0
    v_mov_b32 v64, 0
    v_mov_b32 v65, 0
    v_mov_b32 v66, 0
    v_mov_b32 v67, 0
    v_mov_b32 v68, 0
    v_mov_b32 v69, 0
    v_mov_b32 v70, 0
    v_mov_b32 v71, 0
    v_mov_b32 v72, 0
    v_mov_b32 v73, 0
    v_mov_b32 v74, 0
    v_mov_b32 v75, 0
    v_mov_b32 v76, 0
    v_mov_b32 v77, 0
    v_mov_b32 v78, 0
    v_mov_b32 v79, 0
    v_mov_b32 v80, 0
    v_mov_b32 v81, 0
    v_mov_b32 v82, 0
    v_mov_b32 v83, 0
    v_mov_b32 v84, 0
    v_mov_b32 v85, 0
    v_mov_b32 v86, 0
    v_mov_b32 v87, 0
    v_mov_b32 v88, 0
    v_mov_b32 v89, 0
    v_mov_b32 v90, 0
    v_mov_b32 v91, 0
    v_mov_b32 v92, 0
    v_mov_b32 v93, 0
    v_mov_b32 v94, 0
    v_mov_b32 v95, 0
    s_mul_i32 s29, s24, 4096
    s_mul_i32 s30, s24, 3072
    s_add_u32 s30, s30, 32768
    s_mov_b32 s31, 0
    s_mov_b32 s32, 0
    s_add_u32 m0, s29, 0
    s_nop 0
    buffer_load_dwordx4 v162, s[12:15], s31 offen lds
    s_add_u32 m0, s29, 1024
    s_nop 0
    buffer_load_dwordx4 v163, s[12:15], s31 offen lds
    s_add_u32 m0, s29, 2048
    s_nop 0
    buffer_load_dwordx4 v164, s[12:15], s31 offen lds
    s_add_u32 m0, s29, 3072
    s_nop 0
    buffer_load_dwordx4 v165, s[12:15], s31 offen lds
    s_add_u32 m0, s30, 0
    s_nop 0
    buffer_load_dwordx4 v166, s[16:19], s32 offen lds
    s_add_u32 m0, s30, 1024
    s_nop 0
    buffer_load_dwordx4 v167, s[16:19], s32 offen lds
    s_add_u32 m0, s30, 2048
    s_nop 0
    buffer_load_dwordx4 v168, s[16:19], s32 offen lds
    s_add_u32 s31, s31, 4096
    s_add_u32 s32, s32, 81920
    s_waitcnt vmcnt(0)
    s_barrier
    s_add_u32 m0, s29, 57344
    s_nop 0
    buffer_load_dwordx4 v162, s[12:15], s31 offen lds
    s_add_u32 m0, s29, 58368
    s_nop 0
    buffer_load_dwordx4 v163, s[12:15], s31 offen lds
    s_add_u32 m0, s29, 59392
    s_nop 0
    buffer_load_dwordx4 v164, s[12:15], s31 offen lds
    s_add_u32 m0, s29, 60416
    s_nop 0
    buffer_load_dwordx4 v165, s[12:15], s31 offen lds
    s_add_u32 m0, s30, 57344
    s_nop 0
    buffer_load_dwordx4 v166, s[16:19], s32 offen lds
    s_add_u32 m0, s30, 58368
    s_nop 0
    buffer_load_dwordx4 v167, s[16:19], s32 offen lds
    s_add_u32 m0, s30, 59392
    s_nop 0
    buffer_load_dwordx4 v168, s[16:19], s32 offen lds
    s_add_u32 s31, s31, 61440
    s_add_u32 s32, s32, 81920
    ds_read_b128 v[96:99], v144 offset:0
    ds_read_b64_tr_b16 v[100:101], v152 offset:0
    ds_read_b64_tr_b16 v[102:103], v152 offset:1280
    ds_read_b64_tr_b16 v[104:105], v153 offset:0
    ds_read_b64_tr_b16 v[106:107], v153 offset:1280
    ds_read_b64_tr_b16 v[108:109], v154 offset:0
    ds_read_b64_tr_b16 v[110:111], v154 offset:1280
    ds_read_b64_tr_b16 v[112:113], v155 offset:0
    ds_read_b64_tr_b16 v[114:115], v155 offset:1280
    ds_read_b64_tr_b16 v[116:117], v156 offset:0
    ds_read_b64_tr_b16 v[118:119], v156 offset:1280
    ds_read_b128 v[120:123], v145 offset:0
    ds_read_b64_tr_b16 v[124:125], v152 offset:5120
    ds_read_b64_tr_b16 v[126:127], v152 offset:6400
    ds_read_b64_tr_b16 v[128:129], v153 offset:5120
    ds_read_b64_tr_b16 v[130:131], v153 offset:6400
    ds_read_b64_tr_b16 v[132:133], v154 offset:5120
    ds_read_b64_tr_b16 v[134:135], v154 offset:6400
    ds_read_b64_tr_b16 v[136:137], v155 offset:5120
    ds_read_b64_tr_b16 v[138:139], v155 offset:6400
    ds_read_b64_tr_b16 v[140:141], v156 offset:5120
    ds_read_b64_tr_b16 v[142:143], v156 offset:6400
    s_waitcnt lgkmcnt(11)
    v_mfma_f32_32x32x16_bf16 v[16:31], v[100:103], v[96:99], v[16:31]
    v_mfma_f32_32x32x16_bf16 v[32:47], v[104:107], v[96:99], v[32:47]
    v_mfma_f32_32x32x16_bf16 v[48:63], v[108:111], v[96:99], v[48:63]
    v_mfma_f32_32x32x16_bf16 v[64:79], v[112:115], v[96:99], v[64:79]
    v_mfma_f32_32x32x16_bf16 v[80:95], v[116:119], v[96:99], v[80:95]
    ds_read_b128 v[96:99], v146 offset:0
    ds_read_b64_tr_b16 v[100:101], v152 offset:10240
    ds_read_b64_tr_b16 v[102:103], v152 offset:11520
    ds_read_b64_tr_b16 v[104:105], v153 offset:10240
    ds_read_b64_tr_b16 v[106:107], v153 offset:11520
    ds_read_b64_tr_b16 v[108:109], v154 offset:10240
    ds_read_b64_tr_b16 v[110:111], v154 offset:11520
    ds_read_b64_tr_b16 v[112:113], v155 offset:10240
    ds_read_b64_tr_b16 v[114:115], v155 offset:11520
    ds_read_b64_tr_b16 v[116:117], v156 offset:10240
    ds_read_b64_tr_b16 v[118:119], v156 offset:11520
    s_waitcnt lgkmcnt(11)
    v_mfma_f32_32x32x16_bf16 v[16:31], v[124:127], v[120:123], v[16:31]
    v_mfma_f32_32x32x16_bf16 v[32:47], v[128:131], v[120:123], v[32:47]
    v_mfma_f32_32x32x16_bf16 v[48:63], v[132:135], v[120:123], v[48:63]
    v_mfma_f32_32x32x16_bf16 v[64:79], v[136:139], v[120:123], v[64:79]
    v_mfma_f32_32x32x16_bf16 v[80:95], v[140:143], v[120:123], v[80:95]
    ds_read_b128 v[120:123], v147 offset:0
    ds_read_b64_tr_b16 v[124:125], v152 offset:15360
    ds_read_b64_tr_b16 v[126:127], v152 offset:16640
    ds_read_b64_tr_b16 v[128:129], v153 offset:15360
    ds_read_b64_tr_b16 v[130:131], v153 offset:16640
    ds_read_b64_tr_b16 v[132:133], v154 offset:15360
    ds_read_b64_tr_b16 v[134:135], v154 offset:16640
    ds_read_b64_tr_b16 v[136:137], v155 offset:15360
    ds_read_b64_tr_b16 v[138:139], v155 offset:16640
    ds_read_b64_tr_b16 v[140:141], v156 offset:15360
    ds_read_b64_tr_b16 v[142:143], v156 offset:16640
    s_waitcnt lgkmcnt(11)
    v_mfma_f32_32x32x16_bf16 v[16:31], v[100:103], v[96:99], v[16:31]
    v_mfma_f32_32x32x16_bf16 v[32:47], v[104:107], v[96:99], v[32:47]
    v_mfma_f32_32x32x16_bf16 v[48:63], v[108:111], v[96:99], v[48:63]
    v_mfma_f32_32x32x16_bf16 v[64:79], v[112:115], v[96:99], v[64:79]
    v_mfma_f32_32x32x16_bf16 v[80:95], v[116:119], v[96:99], v[80:95]
    s_waitcnt lgkmcnt(0)
    v_mfma_f32_32x32x16_bf16 v[16:31], v[124:127], v[120:123], v[16:31]
    v_mfma_f32_32x32x16_bf16 v[32:47], v[128:131], v[120:123], v[32:47]
    v_mfma_f32_32x32x16_bf16 v[48:63], v[132:135], v[120:123], v[48:63]
    v_mfma_f32_32x32x16_bf16 v[64:79], v[136:139], v[120:123], v[64:79]
    v_mfma_f32_32x32x16_bf16 v[80:95], v[140:143], v[120:123], v[80:95]
    s_waitcnt vmcnt(0)
    s_barrier
    s_add_u32 m0, s29, 0
    s_nop 0
    buffer_load_dwordx4 v162, s[12:15], s31 offen lds
    s_add_u32 m0, s29, 1024
    s_nop 0
    buffer_load_dwordx4 v163, s[12:15], s31 offen lds
    s_add_u32 m0, s29, 2048
    s_nop 0
    buffer_load_dwordx4 v164, s[12:15], s31 offen lds
    s_add_u32 m0, s29, 3072
    s_nop 0
    buffer_load_dwordx4 v165, s[12:15], s31 offen lds
    s_add_u32 m0, s30, 0
    s_nop 0
    buffer_load_dwordx4 v166, s[16:19], s32 offen lds
    s_add_u32 m0, s30, 1024
    s_nop 0
    buffer_load_dwordx4 v167, s[16:19], s32 offen lds
    s_add_u32 m0, s30, 2048
    s_nop 0
    buffer_load_dwordx4 v168, s[16:19], s32 offen lds
    s_add_u32 s31, s31, 4096
    s_add_u32 s32, s32, 81920
    ds_read_b128 v[96:99], v148 offset:0
    ds_read_b64_tr_b16 v[100:101], v157 offset:0
    ds_read_b64_tr_b16 v[102:103], v157 offset:1280
    ds_read_b64_tr_b16 v[104:105], v158 offset:0
    ds_read_b64_tr_b16 v[106:107], v158 offset:1280
    ds_read_b64_tr_b16 v[108:109], v159 offset:0
    ds_read_b64_tr_b16 v[110:111], v159 offset:1280
    ds_read_b64_tr_b16 v[112:113], v160 offset:0
    ds_read_b64_tr_b16 v[114:115], v160 offset:1280
    ds_read_b64_tr_b16 v[116:117], v161 offset:0
    ds_read_b64_tr_b16 v[118:119], v161 offset:1280
    ds_read_b128 v[120:123], v149 offset:0
    ds_read_b64_tr_b16 v[124:125], v157 offset:5120
    ds_read_b64_tr_b16 v[126:127], v157 offset:6400
    ds_read_b64_tr_b16 v[128:129], v158 offset:5120
    ds_read_b64_tr_b16 v[130:131], v158 offset:6400
    ds_read_b64_tr_b16 v[132:133], v159 offset:5120
    ds_read_b64_tr_b16 v[134:135], v159 offset:6400
    ds_read_b64_tr_b16 v[136:137], v160 offset:5120
    ds_read_b64_tr_b16 v[138:139], v160 offset:6400
    ds_read_b64_tr_b16 v[140:141], v161 offset:5120
    ds_read_b64_tr_b16 v[142:143], v161 offset:6400
    s_waitcnt lgkmcnt(11)
    v_mfma_f32_32x32x16_bf16 v[16:31], v[100:103], v[96:99], v[16:31]
    v_mfma_f32_32x32x16_bf16 v[32:47], v[104:107], v[96:99], v[32:47]
    v_mfma_f32_32x32x16_bf16 v[48:63], v[108:111], v[96:99], v[48:63]
    v_mfma_f32_32x32x16_bf16 v[64:79], v[112:115], v[96:99], v[64:79]
    v_mfma_f32_32x32x16_bf16 v[80:95], v[116:119], v[96:99], v[80:95]
    ds_read_b128 v[96:99], v150 offset:0
    ds_read_b64_tr_b16 v[100:101], v157 offset:10240
    ds_read_b64_tr_b16 v[102:103], v157 offset:11520
    ds_read_b64_tr_b16 v[104:105], v158 offset:10240
    ds_read_b64_tr_b16 v[106:107], v158 offset:11520
    ds_read_b64_tr_b16 v[108:109], v159 offset:10240
    ds_read_b64_tr_b16 v[110:111], v159 offset:11520
    ds_read_b64_tr_b16 v[112:113], v160 offset:10240
    ds_read_b64_tr_b16 v[114:115], v160 offset:11520
    ds_read_b64_tr_b16 v[116:117], v161 offset:10240
    ds_read_b64_tr_b16 v[118:119], v161 offset:11520
    s_waitcnt lgkmcnt(11)
    v_mfma_f32_32x32x16_bf16 v[16:31], v[124:127], v[120:123], v[16:31]
    v_mfma_f32_32x32x16_bf16 v[32:47], v[128:131], v[120:123], v[32:47]
    v_mfma_f32_32x32x16_bf16 v[48:63], v[132:135], v[120:123], v[48:63]
    v_mfma_f32_32x32x16_bf16 v[64:79], v[136:139], v[120:123], v[64:79]
    v_mfma_f32_32x32x16_bf16 v[80:95], v[140:143], v[120:123], v[80:95]
    ds_read_b128 v[120:123], v151 offset:0
    ds_read_b64_tr_b16 v[124:125], v157 offset:15360
    ds_read_b64_tr_b16 v[126:127], v157 offset:16640
    ds_read_b64_tr_b16 v[128:129], v158 offset:15360
    ds_read_b64_tr_b16 v[130:131], v158 offset:16640
    ds_read_b64_tr_b16 v[132:133], v159 offset:15360
    ds_read_b64_tr_b16 v[134:135], v159 offset:16640
    ds_read_b64_tr_b16 v[136:137], v160 offset:15360
    ds_read_b64_tr_b16 v[138:139], v160 offset:16640
    ds_read_b64_tr_b16 v[140:141], v161 offset:15360
    ds_read_b64_tr_b16 v[142:143], v161 offset:16640
    s_waitcnt lgkmcnt(11)
    v_mfma_f32_32x32x16_bf16 v[16:31], v[100:103], v[96:99], v[16:31]
    v_mfma_f32_32x32x16_bf16 v[32:47], v[104:107], v[96:99], v[32:47]
    v_mfma_f32_32x32x16_bf16 v[48:63], v[108:111], v[96:99], v[48:63]
    v_mfma_f32_32x32x16_bf16 v[64:79], v[112:115], v[96:99], v[64:79]
    v_mfma_f32_32x32x16_bf16 v[80:95], v[116:119], v[96:99], v[80:95]
    s_waitcnt lgkmcnt(0)
    v_mfma_f32_32x32x16_bf16 v[16:31], v[124:127], v[120:123], v[16:31]
    v_mfma_f32_32x32x16_bf16 v[32:47], v[128:131], v[120:123], v[32:47]
    v_mfma_f32_32x32x16_bf16 v[48:63], v[132:135], v[120:123], v[48:63]
    v_mfma_f32_32x32x16_bf16 v[64:79], v[136:139], v[120:123], v[64:79]
    v_mfma_f32_32x32x16_bf16 v[80:95], v[140:143], v[120:123], v[80:95]
    s_waitcnt vmcnt(0)
    s_barrier
    s_add_u32 m0, s29, 57344
    s_nop 0
    buffer_load_dwordx4 v162, s[12:15], s31 offen lds
    s_add_u32 m0, s29, 58368
    s_nop 0
    buffer_load_dwordx4 v163, s[12:15], s31 offen lds
    s_add_u32 m0, s29, 59392
    s_nop 0
    buffer_load_dwordx4 v164, s[12:15], s31 offen lds
    s_add_u32 m0, s29, 60416
    s_nop 0
    buffer_load_dwordx4 v165, s[12:15], s31 offen lds
    s_add_u32 m0, s30, 57344
    s_nop 0
    buffer_load_dwordx4 v166, s[16:19], s32 offen lds
    s_add_u32 m0, s30, 58368
    s_nop 0
    buffer_load_dwordx4 v167, s[16:19], s32 offen lds
    s_add_u32 m0, s30, 59392
    s_nop 0
    buffer_load_dwordx4 v168, s[16:19], s32 offen lds
    s_add_u32 s31, s31, 61440
    s_add_u32 s32, s32, 81920
    ds_read_b128 v[96:99], v144 offset:0
    ds_read_b64_tr_b16 v[100:101], v152 offset:0
    ds_read_b64_tr_b16 v[102:103], v152 offset:1280
    ds_read_b64_tr_b16 v[104:105], v153 offset:0
    ds_read_b64_tr_b16 v[106:107], v153 offset:1280
    ds_read_b64_tr_b16 v[108:109], v154 offset:0
    ds_read_b64_tr_b16 v[110:111], v154 offset:1280
    ds_read_b64_tr_b16 v[112:113], v155 offset:0
    ds_read_b64_tr_b16 v[114:115], v155 offset:1280
    ds_read_b64_tr_b16 v[116:117], v156 offset:0
    ds_read_b64_tr_b16 v[118:119], v156 offset:1280
    ds_read_b128 v[120:123], v145 offset:0
    ds_read_b64_tr_b16 v[124:125], v152 offset:5120
    ds_read_b64_tr_b16 v[126:127], v152 offset:6400
    ds_read_b64_tr_b16 v[128:129], v153 offset:5120
    ds_read_b64_tr_b16 v[130:131], v153 offset:6400
    ds_read_b64_tr_b16 v[132:133], v154 offset:5120
    ds_read_b64_tr_b16 v[134:135], v154 offset:6400
    ds_read_b64_tr_b16 v[136:137], v155 offset:5120
    ds_read_b64_tr_b16 v[138:139], v155 offset:6400
    ds_read_b64_tr_b16 v[140:141], v156 offset:5120
    ds_read_b64_tr_b16 v[142:143], v156 offset:6400
    s_waitcnt lgkmcnt(11)
    v_mfma_f32_32x32x16_bf16 v[16:31], v[100:103], v[96:99], v[16:31]
    v_mfma_f32_32x32x16_bf16 v[32:47], v[104:107], v[96:99], v[32:47]
    v_mfma_f32_32x32x16_bf16 v[48:63], v[108:111], v[96:99], v[48:63]
    v_mfma_f32_32x32x16_bf16 v[64:79], v[112:115], v[96:99], v[64:79]
    v_mfma_f32_32x32x16_bf16 v[80:95], v[116:119], v[96:99], v[80:95]
    ds_read_b128 v[96:99], v146 offset:0
    ds_read_b64_tr_b16 v[100:101], v152 offset:10240
    ds_read_b64_tr_b16 v[102:103], v152 offset:11520
    ds_read_b64_tr_b16 v[104:105], v153 offset:10240
    ds_read_b64_tr_b16 v[106:107], v153 offset:11520
    ds_read_b64_tr_b16 v[108:109], v154 offset:10240
    ds_read_b64_tr_b16 v[110:111], v154 offset:11520
    ds_read_b64_tr_b16 v[112:113], v155 offset:10240
    ds_read_b64_tr_b16 v[114:115], v155 offset:11520
    ds_read_b64_tr_b16 v[116:117], v156 offset:10240
    ds_read_b64_tr_b16 v[118:119], v156 offset:11520
    s_waitcnt lgkmcnt(11)
    v_mfma_f32_32x32x16_bf16 v[16:31], v[124:127], v[120:123], v[16:31]
    v_mfma_f32_32x32x16_bf16 v[32:47], v[128:131], v[120:123], v[32:47]
    v_mfma_f32_32x32x16_bf16 v[48:63], v[132:135], v[120:123], v[48:63]
    v_mfma_f32_32x32x16_bf16 v[64:79], v[136:139], v[120:123], v[64:79]
    v_mfma_f32_32x32x16_bf16 v[80:95], v[140:143], v[120:123], v[80:95]
    ds_read_b128 v[120:123], v147 offset:0
    ds_read_b64_tr_b16 v[124:125], v152 offset:15360
    ds_read_b64_tr_b16 v[126:127], v152 offset:16640
    ds_read_b64_tr_b16 v[128:129], v153 offset:15360
    ds_read_b64_tr_b16 v[130:131], v153 offset:16640
    ds_read_b64_tr_b16 v[132:133], v154 offset:15360
    ds_read_b64_tr_b16 v[134:135], v154 offset:16640
    ds_read_b64_tr_b16 v[136:137], v155 offset:15360
    ds_read_b64_tr_b16 v[138:139], v155 offset:16640
    ds_read_b64_tr_b16 v[140:141], v156 offset:15360
    ds_read_b64_tr_b16 v[142:143], v156 offset:16640
    s_waitcnt lgkmcnt(11)
    v_mfma_f32_32x32x16_bf16 v[16:31], v[100:103], v[96:99], v[16:31]
    v_mfma_f32_32x32x16_bf16 v[32:47], v[104:107], v[96:99], v[32:47]
    v_mfma_f32_32x32x16_bf16 v[48:63], v[108:111], v[96:99], v[48:63]
    v_mfma_f32_32x32x16_bf16 v[64:79], v[112:115], v[96:99], v[64:79]
    v_mfma_f32_32x32x16_bf16 v[80:95], v[116:119], v[96:99], v[80:95]
    s_waitcnt lgkmcnt(0)
    v_mfma_f32_32x32x16_bf16 v[16:31], v[124:127], v[120:123], v[16:31]
    v_mfma_f32_32x32x16_bf16 v[32:47], v[128:131], v[120:123], v[32:47]
    v_mfma_f32_32x32x16_bf16 v[48:63], v[132:135], v[120:123], v[48:63]
    v_mfma_f32_32x32x16_bf16 v[64:79], v[136:139], v[120:123], v[64:79]
    v_mfma_f32_32x32x16_bf16 v[80:95], v[140:143], v[120:123], v[80:95]
    s_waitcnt vmcnt(0)
    s_barrier
    s_add_u32 m0, s29, 0
    s_nop 0
    buffer_load_dwordx4 v162, s[12:15], s31 offen lds
    s_add_u32 m0, s29, 1024
    s_nop 0
    buffer_load_dwordx4 v163, s[12:15], s31 offen lds
    s_add_u32 m0, s29, 2048
    s_nop 0
    buffer_load_dwordx4 v164, s[12:15], s31 offen lds
    s_add_u32 m0, s29, 3072
    s_nop 0
    buffer_load_dwordx4 v165, s[12:15], s31 offen lds
    s_add_u32 m0, s30, 0
    s_nop 0
    buffer_load_dwordx4 v166, s[16:19], s32 offen lds
    s_add_u32 m0, s30, 1024
    s_nop 0
    buffer_load_dwordx4 v167, s[16:19], s32 offen lds
    s_add_u32 m0, s30, 2048
    s_nop 0
    buffer_load_dwordx4 v168, s[16:19], s32 offen lds
    s_add_u32 s31, s31, 4096
    s_add_u32 s32, s32, 81920
    ds_read_b128 v[96:99], v148 offset:0
    ds_read_b64_tr_b16 v[100:101], v157 offset:0
    ds_read_b64_tr_b16 v[102:103], v157 offset:1280
    ds_read_b64_tr_b16 v[104:105], v158 offset:0
    ds_read_b64_tr_b16 v[106:107], v158 offset:1280
    ds_read_b64_tr_b16 v[108:109], v159 offset:0
    ds_read_b64_tr_b16 v[110:111], v159 offset:1280
    ds_read_b64_tr_b16 v[112:113], v160 offset:0
    ds_read_b64_tr_b16 v[114:115], v160 offset:1280
    ds_read_b64_tr_b16 v[116:117], v161 offset:0
    ds_read_b64_tr_b16 v[118:119], v161 offset:1280
    ds_read_b128 v[120:123], v149 offset:0
    ds_read_b64_tr_b16 v[124:125], v157 offset:5120
    ds_read_b64_tr_b16 v[126:127], v157 offset:6400
    ds_read_b64_tr_b16 v[128:129], v158 offset:5120
    ds_read_b64_tr_b16 v[130:131], v158 offset:6400
    ds_read_b64_tr_b16 v[132:133], v159 offset:5120
    ds_read_b64_tr_b16 v[134:135], v159 offset:6400
    ds_read_b64_tr_b16 v[136:137], v160 offset:5120
    ds_read_b64_tr_b16 v[138:139], v160 offset:6400
    ds_read_b64_tr_b16 v[140:141], v161 offset:5120
    ds_read_b64_tr_b16 v[142:143], v161 offset:6400
    s_waitcnt lgkmcnt(11)
    v_mfma_f32_32x32x16_bf16 v[16:31], v[100:103], v[96:99], v[16:31]
    v_mfma_f32_32x32x16_bf16 v[32:47], v[104:107], v[96:99], v[32:47]
    v_mfma_f32_32x32x16_bf16 v[48:63], v[108:111], v[96:99], v[48:63]
    v_mfma_f32_32x32x16_bf16 v[64:79], v[112:115], v[96:99], v[64:79]
    v_mfma_f32_32x32x16_bf16 v[80:95], v[116:119], v[96:99], v[80:95]
    ds_read_b128 v[96:99], v150 offset:0
    ds_read_b64_tr_b16 v[100:101], v157 offset:10240
    ds_read_b64_tr_b16 v[102:103], v157 offset:11520
    ds_read_b64_tr_b16 v[104:105], v158 offset:10240
    ds_read_b64_tr_b16 v[106:107], v158 offset:11520
    ds_read_b64_tr_b16 v[108:109], v159 offset:10240
    ds_read_b64_tr_b16 v[110:111], v159 offset:11520
    ds_read_b64_tr_b16 v[112:113], v160 offset:10240
    ds_read_b64_tr_b16 v[114:115], v160 offset:11520
    ds_read_b64_tr_b16 v[116:117], v161 offset:10240
    ds_read_b64_tr_b16 v[118:119], v161 offset:11520
    s_waitcnt lgkmcnt(11)
    v_mfma_f32_32x32x16_bf16 v[16:31], v[124:127], v[120:123], v[16:31]
    v_mfma_f32_32x32x16_bf16 v[32:47], v[128:131], v[120:123], v[32:47]
    v_mfma_f32_32x32x16_bf16 v[48:63], v[132:135], v[120:123], v[48:63]
    v_mfma_f32_32x32x16_bf16 v[64:79], v[136:139], v[120:123], v[64:79]
    v_mfma_f32_32x32x16_bf16 v[80:95], v[140:143], v[120:123], v[80:95]
    ds_read_b128 v[120:123], v151 offset:0
    ds_read_b64_tr_b16 v[124:125], v157 offset:15360
    ds_read_b64_tr_b16 v[126:127], v157 offset:16640
    ds_read_b64_tr_b16 v[128:129], v158 offset:15360
    ds_read_b64_tr_b16 v[130:131], v158 offset:16640
    ds_read_b64_tr_b16 v[132:133], v159 offset:15360
    ds_read_b64_tr_b16 v[134:135], v159 offset:16640
    ds_read_b64_tr_b16 v[136:137], v160 offset:15360
    ds_read_b64_tr_b16 v[138:139], v160 offset:16640
    ds_read_b64_tr_b16 v[140:141], v161 offset:15360
    ds_read_b64_tr_b16 v[142:143], v161 offset:16640
    s_waitcnt lgkmcnt(11)
    v_mfma_f32_32x32x16_bf16 v[16:31], v[100:103], v[96:99], v[16:31]
    v_mfma_f32_32x32x16_bf16 v[32:47], v[104:107], v[96:99], v[32:47]
    v_mfma_f32_32x32x16_bf16 v[48:63], v[108:111], v[96:99], v[48:63]
    v_mfma_f32_32x32x16_bf16 v[64:79], v[112:115], v[96:99], v[64:79]
    v_mfma_f32_32x32x16_bf16 v[80:95], v[116:119], v[96:99], v[80:95]
    s_waitcnt lgkmcnt(0)
    v_mfma_f32_32x32x16_bf16 v[16:31], v[124:127], v[120:123], v[16:31]
    v_mfma_f32_32x32x16_bf16 v[32:47], v[128:131], v[120:123], v[32:47]
    v_mfma_f32_32x32x16_bf16 v[48:63], v[132:135], v[120:123], v[48:63]
    v_mfma_f32_32x32x16_bf16 v[64:79], v[136:139], v[120:123], v[64:79]
    v_mfma_f32_32x32x16_bf16 v[80:95], v[140:143], v[120:123], v[80:95]
    s_waitcnt vmcnt(0)
    s_barrier
    s_add_u32 m0, s29, 57344
    s_nop 0
    buffer_load_dwordx4 v162, s[12:15], s31 offen lds
    s_add_u32 m0, s29, 58368
    s_nop 0
    buffer_load_dwordx4 v163, s[12:15], s31 offen lds
    s_add_u32 m0, s29, 59392
    s_nop 0
    buffer_load_dwordx4 v164, s[12:15], s31 offen lds
    s_add_u32 m0, s29, 60416
    s_nop 0
    buffer_load_dwordx4 v165, s[12:15], s31 offen lds
    s_add_u32 m0, s30, 57344
    s_nop 0
    buffer_load_dwordx4 v166, s[16:19], s32 offen lds
    s_add_u32 m0, s30, 58368
    s_nop 0
    buffer_load_dwordx4 v167, s[16:19], s32 offen lds
    s_add_u32 m0, s30, 59392
    s_nop 0
    buffer_load_dwordx4 v168, s[16:19], s32 offen lds
    s_add_u32 s31, s31, 61440
    s_add_u32 s32, s32, 81920
    ds_read_b128 v[96:99], v144 offset:0
    ds_read_b64_tr_b16 v[100:101], v152 offset:0
    ds_read_b64_tr_b16 v[102:103], v152 offset:1280
    ds_read_b64_tr_b16 v[104:105], v153 offset:0
    ds_read_b64_tr_b16 v[106:107], v153 offset:1280
    ds_read_b64_tr_b16 v[108:109], v154 offset:0
    ds_read_b64_tr_b16 v[110:111], v154 offset:1280
    ds_read_b64_tr_b16 v[112:113], v155 offset:0
    ds_read_b64_tr_b16 v[114:115], v155 offset:1280
    ds_read_b64_tr_b16 v[116:117], v156 offset:0
    ds_read_b64_tr_b16 v[118:119], v156 offset:1280
    ds_read_b128 v[120:123], v145 offset:0
    ds_read_b64_tr_b16 v[124:125], v152 offset:5120
    ds_read_b64_tr_b16 v[126:127], v152 offset:6400
    ds_read_b64_tr_b16 v[128:129], v153 offset:5120
    ds_read_b64_tr_b16 v[130:131], v153 offset:6400
    ds_read_b64_tr_b16 v[132:133], v154 offset:5120
    ds_read_b64_tr_b16 v[134:135], v154 offset:6400
    ds_read_b64_tr_b16 v[136:137], v155 offset:5120
    ds_read_b64_tr_b16 v[138:139], v155 offset:6400
    ds_read_b64_tr_b16 v[140:141], v156 offset:5120
    ds_read_b64_tr_b16 v[142:143], v156 offset:6400
    s_waitcnt lgkmcnt(11)
    v_mfma_f32_32x32x16_bf16 v[16:31], v[100:103], v[96:99], v[16:31]
    v_mfma_f32_32x32x16_bf16 v[32:47], v[104:107], v[96:99], v[32:47]
    v_mfma_f32_32x32x16_bf16 v[48:63], v[108:111], v[96:99], v[48:63]
    v_mfma_f32_32x32x16_bf16 v[64:79], v[112:115], v[96:99], v[64:79]
    v_mfma_f32_32x32x16_bf16 v[80:95], v[116:119], v[96:99], v[80:95]
    ds_read_b128 v[96:99], v146 offset:0
    ds_read_b64_tr_b16 v[100:101], v152 offset:10240
    ds_read_b64_tr_b16 v[102:103], v152 offset:11520
    ds_read_b64_tr_b16 v[104:105], v153 offset:10240
    ds_read_b64_tr_b16 v[106:107], v153 offset:11520
    ds_read_b64_tr_b16 v[108:109], v154 offset:10240
    ds_read_b64_tr_b16 v[110:111], v154 offset:11520
    ds_read_b64_tr_b16 v[112:113], v155 offset:10240
    ds_read_b64_tr_b16 v[114:115], v155 offset:11520
    ds_read_b64_tr_b16 v[116:117], v156 offset:10240
    ds_read_b64_tr_b16 v[118:119], v156 offset:11520
    s_waitcnt lgkmcnt(11)
    v_mfma_f32_32x32x16_bf16 v[16:31], v[124:127], v[120:123], v[16:31]
    v_mfma_f32_32x32x16_bf16 v[32:47], v[128:131], v[120:123], v[32:47]
    v_mfma_f32_32x32x16_bf16 v[48:63], v[132:135], v[120:123], v[48:63]
    v_mfma_f32_32x32x16_bf16 v[64:79], v[136:139], v[120:123], v[64:79]
    v_mfma_f32_32x32x16_bf16 v[80:95], v[140:143], v[120:123], v[80:95]
    ds_read_b128 v[120:123], v147 offset:0
    ds_read_b64_tr_b16 v[124:125], v152 offset:15360
    ds_read_b64_tr_b16 v[126:127], v152 offset:16640
    ds_read_b64_tr_b16 v[128:129], v153 offset:15360
    ds_read_b64_tr_b16 v[130:131], v153 offset:16640
    ds_read_b64_tr_b16 v[132:133], v154 offset:15360
    ds_read_b64_tr_b16 v[134:135], v154 offset:16640
    ds_read_b64_tr_b16 v[136:137], v155 offset:15360
    ds_read_b64_tr_b16 v[138:139], v155 offset:16640
    ds_read_b64_tr_b16 v[140:141], v156 offset:15360
    ds_read_b64_tr_b16 v[142:143], v156 offset:16640
    s_waitcnt lgkmcnt(11)
    v_mfma_f32_32x32x16_bf16 v[16:31], v[100:103], v[96:99], v[16:31]
    v_mfma_f32_32x32x16_bf16 v[32:47], v[104:107], v[96:99], v[32:47]
    v_mfma_f32_32x32x16_bf16 v[48:63], v[108:111], v[96:99], v[48:63]
    v_mfma_f32_32x32x16_bf16 v[64:79], v[112:115], v[96:99], v[64:79]
    v_mfma_f32_32x32x16_bf16 v[80:95], v[116:119], v[96:99], v[80:95]
    s_waitcnt lgkmcnt(0)
    v_mfma_f32_32x32x16_bf16 v[16:31], v[124:127], v[120:123], v[16:31]
    v_mfma_f32_32x32x16_bf16 v[32:47], v[128:131], v[120:123], v[32:47]
    v_mfma_f32_32x32x16_bf16 v[48:63], v[132:135], v[120:123], v[48:63]
    v_mfma_f32_32x32x16_bf16 v[64:79], v[136:139], v[120:123], v[64:79]
    v_mfma_f32_32x32x16_bf16 v[80:95], v[140:143], v[120:123], v[80:95]
    s_waitcnt vmcnt(0)
    s_barrier
    s_add_u32 m0, s29, 0
    s_nop 0
    buffer_load_dwordx4 v162, s[12:15], s31 offen lds
    s_add_u32 m0, s29, 1024
    s_nop 0
    buffer_load_dwordx4 v163, s[12:15], s31 offen lds
    s_add_u32 m0, s29, 2048
    s_nop 0
    buffer_load_dwordx4 v164, s[12:15], s31 offen lds
    s_add_u32 m0, s29, 3072
    s_nop 0
    buffer_load_dwordx4 v165, s[12:15], s31 offen lds
    s_add_u32 m0, s30, 0
    s_nop 0
    buffer_load_dwordx4 v166, s[16:19], s32 offen lds
    s_add_u32 m0, s30, 1024
    s_nop 0
    buffer_load_dwordx4 v167, s[16:19], s32 offen lds
    s_add_u32 m0, s30, 2048
    s_nop 0
    buffer_load_dwordx4 v168, s[16:19], s32 offen lds
    s_add_u32 s31, s31, 4096
    s_add_u32 s32, s32, 81920
    ds_read_b128 v[96:99], v148 offset:0
    ds_read_b64_tr_b16 v[100:101], v157 offset:0
    ds_read_b64_tr_b16 v[102:103], v157 offset:1280
    ds_read_b64_tr_b16 v[104:105], v158 offset:0
    ds_read_b64_tr_b16 v[106:107], v158 offset:1280
    ds_read_b64_tr_b16 v[108:109], v159 offset:0
    ds_read_b64_tr_b16 v[110:111], v159 offset:1280
    ds_read_b64_tr_b16 v[112:113], v160 offset:0
    ds_read_b64_tr_b16 v[114:115], v160 offset:1280
    ds_read_b64_tr_b16 v[116:117], v161 offset:0
    ds_read_b64_tr_b16 v[118:119], v161 offset:1280
    ds_read_b128 v[120:123], v149 offset:0
    ds_read_b64_tr_b16 v[124:125], v157 offset:5120
    ds_read_b64_tr_b16 v[126:127], v157 offset:6400
    ds_read_b64_tr_b16 v[128:129], v158 offset:5120
    ds_read_b64_tr_b16 v[130:131], v158 offset:6400
    ds_read_b64_tr_b16 v[132:133], v159 offset:5120
    ds_read_b64_tr_b16 v[134:135], v159 offset:6400
    ds_read_b64_tr_b16 v[136:137], v160 offset:5120
    ds_read_b64_tr_b16 v[138:139], v160 offset:6400
    ds_read_b64_tr_b16 v[140:141], v161 offset:5120
    ds_read_b64_tr_b16 v[142:143], v161 offset:6400
    s_waitcnt lgkmcnt(11)
    v_mfma_f32_32x32x16_bf16 v[16:31], v[100:103], v[96:99], v[16:31]
    v_mfma_f32_32x32x16_bf16 v[32:47], v[104:107], v[96:99], v[32:47]
    v_mfma_f32_32x32x16_bf16 v[48:63], v[108:111], v[96:99], v[48:63]
    v_mfma_f32_32x32x16_bf16 v[64:79], v[112:115], v[96:99], v[64:79]
    v_mfma_f32_32x32x16_bf16 v[80:95], v[116:119], v[96:99], v[80:95]
    ds_read_b128 v[96:99], v150 offset:0
    ds_read_b64_tr_b16 v[100:101], v157 offset:10240
    ds_read_b64_tr_b16 v[102:103], v157 offset:11520
    ds_read_b64_tr_b16 v[104:105], v158 offset:10240
    ds_read_b64_tr_b16 v[106:107], v158 offset:11520
    ds_read_b64_tr_b16 v[108:109], v159 offset:10240
    ds_read_b64_tr_b16 v[110:111], v159 offset:11520
    ds_read_b64_tr_b16 v[112:113], v160 offset:10240
    ds_read_b64_tr_b16 v[114:115], v160 offset:11520
    ds_read_b64_tr_b16 v[116:117], v161 offset:10240
    ds_read_b64_tr_b16 v[118:119], v161 offset:11520
    s_waitcnt lgkmcnt(11)
    v_mfma_f32_32x32x16_bf16 v[16:31], v[124:127], v[120:123], v[16:31]
    v_mfma_f32_32x32x16_bf16 v[32:47], v[128:131], v[120:123], v[32:47]
    v_mfma_f32_32x32x16_bf16 v[48:63], v[132:135], v[120:123], v[48:63]
    v_mfma_f32_32x32x16_bf16 v[64:79], v[136:139], v[120:123], v[64:79]
    v_mfma_f32_32x32x16_bf16 v[80:95], v[140:143], v[120:123], v[80:95]
    ds_read_b128 v[120:123], v151 offset:0
    ds_read_b64_tr_b16 v[124:125], v157 offset:15360
    ds_read_b64_tr_b16 v[126:127], v157 offset:16640
    ds_read_b64_tr_b16 v[128:129], v158 offset:15360
    ds_read_b64_tr_b16 v[130:131], v158 offset:16640
    ds_read_b64_tr_b16 v[132:133], v159 offset:15360
    ds_read_b64_tr_b16 v[134:135], v159 offset:16640
    ds_read_b64_tr_b16 v[136:137], v160 offset:15360
    ds_read_b64_tr_b16 v[138:139], v160 offset:16640
    ds_read_b64_tr_b16 v[140:141], v161 offset:15360
    ds_read_b64_tr_b16 v[142:143], v161 offset:16640
    s_waitcnt lgkmcnt(11)
    v_mfma_f32_32x32x16_bf16 v[16:31], v[100:103], v[96:99], v[16:31]
    v_mfma_f32_32x32x16_bf16 v[32:47], v[104:107], v[96:99], v[32:47]
    v_mfma_f32_32x32x16_bf16 v[48:63], v[108:111], v[96:99], v[48:63]
    v_mfma_f32_32x32x16_bf16 v[64:79], v[112:115], v[96:99], v[64:79]
    v_mfma_f32_32x32x16_bf16 v[80:95], v[116:119], v[96:99], v[80:95]
    s_waitcnt lgkmcnt(0)
    v_mfma_f32_32x32x16_bf16 v[16:31], v[124:127], v[120:123], v[16:31]
    v_mfma_f32_32x32x16_bf16 v[32:47], v[128:131], v[120:123], v[32:47]
    v_mfma_f32_32x32x16_bf16 v[48:63], v[132:135], v[120:123], v[48:63]
    v_mfma_f32_32x32x16_bf16 v[64:79], v[136:139], v[120:123], v[64:79]
    v_mfma_f32_32x32x16_bf16 v[80:95], v[140:143], v[120:123], v[80:95]
    s_waitcnt vmcnt(0)
    s_barrier
    s_add_u32 m0, s29, 57344
    s_nop 0
    buffer_load_dwordx4 v162, s[12:15], s31 offen lds
    s_add_u32 m0, s29, 58368
    s_nop 0
    buffer_load_dwordx4 v163, s[12:15], s31 offen lds
    s_add_u32 m0, s29, 59392
    s_nop 0
    buffer_load_dwordx4 v164, s[12:15], s31 offen lds
    s_add_u32 m0, s29, 60416
    s_nop 0
    buffer_load_dwordx4 v165, s[12:15], s31 offen lds
    s_add_u32 m0, s30, 57344
    s_nop 0
    buffer_load_dwordx4 v166, s[16:19], s32 offen lds
    s_add_u32 m0, s30, 58368
    s_nop 0
    buffer_load_dwordx4 v167, s[16:19], s32 offen lds
    s_add_u32 m0, s30, 59392
    s_nop 0
    buffer_load_dwordx4 v168, s[16:19], s32 offen lds
    s_add_u32 s31, s31, 61440
    s_add_u32 s32, s32, 81920
    ds_read_b128 v[96:99], v144 offset:0
    ds_read_b64_tr_b16 v[100:101], v152 offset:0
    ds_read_b64_tr_b16 v[102:103], v152 offset:1280
    ds_read_b64_tr_b16 v[104:105], v153 offset:0
    ds_read_b64_tr_b16 v[106:107], v153 offset:1280
    ds_read_b64_tr_b16 v[108:109], v154 offset:0
    ds_read_b64_tr_b16 v[110:111], v154 offset:1280
    ds_read_b64_tr_b16 v[112:113], v155 offset:0
    ds_read_b64_tr_b16 v[114:115], v155 offset:1280
    ds_read_b64_tr_b16 v[116:117], v156 offset:0
    ds_read_b64_tr_b16 v[118:119], v156 offset:1280
    ds_read_b128 v[120:123], v145 offset:0
    ds_read_b64_tr_b16 v[124:125], v152 offset:5120
    ds_read_b64_tr_b16 v[126:127], v152 offset:6400
    ds_read_b64_tr_b16 v[128:129], v153 offset:5120
    ds_read_b64_tr_b16 v[130:131], v153 offset:6400
    ds_read_b64_tr_b16 v[132:133], v154 offset:5120
    ds_read_b64_tr_b16 v[134:135], v154 offset:6400
    ds_read_b64_tr_b16 v[136:137], v155 offset:5120
    ds_read_b64_tr_b16 v[138:139], v155 offset:6400
    ds_read_b64_tr_b16 v[140:141], v156 offset:5120
    ds_read_b64_tr_b16 v[142:143], v156 offset:6400
    s_waitcnt lgkmcnt(11)
    v_mfma_f32_32x32x16_bf16 v[16:31], v[100:103], v[96:99], v[16:31]
    v_mfma_f32_32x32x16_bf16 v[32:47], v[104:107], v[96:99], v[32:47]
    v_mfma_f32_32x32x16_bf16 v[48:63], v[108:111], v[96:99], v[48:63]
    v_mfma_f32_32x32x16_bf16 v[64:79], v[112:115], v[96:99], v[64:79]
    v_mfma_f32_32x32x16_bf16 v[80:95], v[116:119], v[96:99], v[80:95]
    ds_read_b128 v[96:99], v146 offset:0
    ds_read_b64_tr_b16 v[100:101], v152 offset:10240
    ds_read_b64_tr_b16 v[102:103], v152 offset:11520
    ds_read_b64_tr_b16 v[104:105], v153 offset:10240
    ds_read_b64_tr_b16 v[106:107], v153 offset:11520
    ds_read_b64_tr_b16 v[108:109], v154 offset:10240
    ds_read_b64_tr_b16 v[110:111], v154 offset:11520
    ds_read_b64_tr_b16 v[112:113], v155 offset:10240
    ds_read_b64_tr_b16 v[114:115], v155 offset:11520
    ds_read_b64_tr_b16 v[116:117], v156 offset:10240
    ds_read_b64_tr_b16 v[118:119], v156 offset:11520
    s_waitcnt lgkmcnt(11)
    v_mfma_f32_32x32x16_bf16 v[16:31], v[124:127], v[120:123], v[16:31]
    v_mfma_f32_32x32x16_bf16 v[32:47], v[128:131], v[120:123], v[32:47]
    v_mfma_f32_32x32x16_bf16 v[48:63], v[132:135], v[120:123], v[48:63]
    v_mfma_f32_32x32x16_bf16 v[64:79], v[136:139], v[120:123], v[64:79]
    v_mfma_f32_32x32x16_bf16 v[80:95], v[140:143], v[120:123], v[80:95]
    ds_read_b128 v[120:123], v147 offset:0
    ds_read_b64_tr_b16 v[124:125], v152 offset:15360
    ds_read_b64_tr_b16 v[126:127], v152 offset:16640
    ds_read_b64_tr_b16 v[128:129], v153 offset:15360
    ds_read_b64_tr_b16 v[130:131], v153 offset:16640
    ds_read_b64_tr_b16 v[132:133], v154 offset:15360
    ds_read_b64_tr_b16 v[134:135], v154 offset:16640
    ds_read_b64_tr_b16 v[136:137], v155 offset:15360
    ds_read_b64_tr_b16 v[138:139], v155 offset:16640
    ds_read_b64_tr_b16 v[140:141], v156 offset:15360
    ds_read_b64_tr_b16 v[142:143], v156 offset:16640
    s_waitcnt lgkmcnt(11)
    v_mfma_f32_32x32x16_bf16 v[16:31], v[100:103], v[96:99], v[16:31]
    v_mfma_f32_32x32x16_bf16 v[32:47], v[104:107], v[96:99], v[32:47]
    v_mfma_f32_32x32x16_bf16 v[48:63], v[108:111], v[96:99], v[48:63]
    v_mfma_f32_32x32x16_bf16 v[64:79], v[112:115], v[96:99], v[64:79]
    v_mfma_f32_32x32x16_bf16 v[80:95], v[116:119], v[96:99], v[80:95]
    s_waitcnt lgkmcnt(0)
    v_mfma_f32_32x32x16_bf16 v[16:31], v[124:127], v[120:123], v[16:31]
    v_mfma_f32_32x32x16_bf16 v[32:47], v[128:131], v[120:123], v[32:47]
    v_mfma_f32_32x32x16_bf16 v[48:63], v[132:135], v[120:123], v[48:63]
    v_mfma_f32_32x32x16_bf16 v[64:79], v[136:139], v[120:123], v[64:79]
    v_mfma_f32_32x32x16_bf16 v[80:95], v[140:143], v[120:123], v[80:95]
    s_waitcnt vmcnt(0)
    s_barrier
    s_add_u32 m0, s29, 0
    s_nop 0
    buffer_load_dwordx4 v162, s[12:15], s31 offen lds
    s_add_u32 m0, s29, 1024
    s_nop 0
    buffer_load_dwordx4 v163, s[12:15], s31 offen lds
    s_add_u32 m0, s29, 2048
    s_nop 0
    buffer_load_dwordx4 v164, s[12:15], s31 offen lds
    s_add_u32 m0, s29, 3072
    s_nop 0
    buffer_load_dwordx4 v165, s[12:15], s31 offen lds
    s_add_u32 m0, s30, 0
    s_nop 0
    buffer_load_dwordx4 v166, s[16:19], s32 offen lds
    s_add_u32 m0, s30, 1024
    s_nop 0
    buffer_load_dwordx4 v167, s[16:19], s32 offen lds
    s_add_u32 m0, s30, 2048
    s_nop 0
    buffer_load_dwordx4 v168, s[16:19], s32 offen lds
    s_add_u32 s31, s31, 4096
    s_add_u32 s32, s32, 81920
    ds_read_b128 v[96:99], v148 offset:0
    ds_read_b64_tr_b16 v[100:101], v157 offset:0
    ds_read_b64_tr_b16 v[102:103], v157 offset:1280
    ds_read_b64_tr_b16 v[104:105], v158 offset:0
    ds_read_b64_tr_b16 v[106:107], v158 offset:1280
    ds_read_b64_tr_b16 v[108:109], v159 offset:0
    ds_read_b64_tr_b16 v[110:111], v159 offset:1280
    ds_read_b64_tr_b16 v[112:113], v160 offset:0
    ds_read_b64_tr_b16 v[114:115], v160 offset:1280
    ds_read_b64_tr_b16 v[116:117], v161 offset:0
    ds_read_b64_tr_b16 v[118:119], v161 offset:1280
    ds_read_b128 v[120:123], v149 offset:0
    ds_read_b64_tr_b16 v[124:125], v157 offset:5120
    ds_read_b64_tr_b16 v[126:127], v157 offset:6400
    ds_read_b64_tr_b16 v[128:129], v158 offset:5120
    ds_read_b64_tr_b16 v[130:131], v158 offset:6400
    ds_read_b64_tr_b16 v[132:133], v159 offset:5120
    ds_read_b64_tr_b16 v[134:135], v159 offset:6400
    ds_read_b64_tr_b16 v[136:137], v160 offset:5120
    ds_read_b64_tr_b16 v[138:139], v160 offset:6400
    ds_read_b64_tr_b16 v[140:141], v161 offset:5120
    ds_read_b64_tr_b16 v[142:143], v161 offset:6400
    s_waitcnt lgkmcnt(11)
    v_mfma_f32_32x32x16_bf16 v[16:31], v[100:103], v[96:99], v[16:31]
    v_mfma_f32_32x32x16_bf16 v[32:47], v[104:107], v[96:99], v[32:47]
    v_mfma_f32_32x32x16_bf16 v[48:63], v[108:111], v[96:99], v[48:63]
    v_mfma_f32_32x32x16_bf16 v[64:79], v[112:115], v[96:99], v[64:79]
    v_mfma_f32_32x32x16_bf16 v[80:95], v[116:119], v[96:99], v[80:95]
    ds_read_b128 v[96:99], v150 offset:0
    ds_read_b64_tr_b16 v[100:101], v157 offset:10240
    ds_read_b64_tr_b16 v[102:103], v157 offset:11520
    ds_read_b64_tr_b16 v[104:105], v158 offset:10240
    ds_read_b64_tr_b16 v[106:107], v158 offset:11520
    ds_read_b64_tr_b16 v[108:109], v159 offset:10240
    ds_read_b64_tr_b16 v[110:111], v159 offset:11520
    ds_read_b64_tr_b16 v[112:113], v160 offset:10240
    ds_read_b64_tr_b16 v[114:115], v160 offset:11520
    ds_read_b64_tr_b16 v[116:117], v161 offset:10240
    ds_read_b64_tr_b16 v[118:119], v161 offset:11520
    s_waitcnt lgkmcnt(11)
    v_mfma_f32_32x32x16_bf16 v[16:31], v[124:127], v[120:123], v[16:31]
    v_mfma_f32_32x32x16_bf16 v[32:47], v[128:131], v[120:123], v[32:47]
    v_mfma_f32_32x32x16_bf16 v[48:63], v[132:135], v[120:123], v[48:63]
    v_mfma_f32_32x32x16_bf16 v[64:79], v[136:139], v[120:123], v[64:79]
    v_mfma_f32_32x32x16_bf16 v[80:95], v[140:143], v[120:123], v[80:95]
    ds_read_b128 v[120:123], v151 offset:0
    ds_read_b64_tr_b16 v[124:125], v157 offset:15360
    ds_read_b64_tr_b16 v[126:127], v157 offset:16640
    ds_read_b64_tr_b16 v[128:129], v158 offset:15360
    ds_read_b64_tr_b16 v[130:131], v158 offset:16640
    ds_read_b64_tr_b16 v[132:133], v159 offset:15360
    ds_read_b64_tr_b16 v[134:135], v159 offset:16640
    ds_read_b64_tr_b16 v[136:137], v160 offset:15360
    ds_read_b64_tr_b16 v[138:139], v160 offset:16640
    ds_read_b64_tr_b16 v[140:141], v161 offset:15360
    ds_read_b64_tr_b16 v[142:143], v161 offset:16640
    s_waitcnt lgkmcnt(11)
    v_mfma_f32_32x32x16_bf16 v[16:31], v[100:103], v[96:99], v[16:31]
    v_mfma_f32_32x32x16_bf16 v[32:47], v[104:107], v[96:99], v[32:47]
    v_mfma_f32_32x32x16_bf16 v[48:63], v[108:111], v[96:99], v[48:63]
    v_mfma_f32_32x32x16_bf16 v[64:79], v[112:115], v[96:99], v[64:79]
    v_mfma_f32_32x32x16_bf16 v[80:95], v[116:119], v[96:99], v[80:95]
    s_waitcnt lgkmcnt(0)
    v_mfma_f32_32x32x16_bf16 v[16:31], v[124:127], v[120:123], v[16:31]
    v_mfma_f32_32x32x16_bf16 v[32:47], v[128:131], v[120:123], v[32:47]
    v_mfma_f32_32x32x16_bf16 v[48:63], v[132:135], v[120:123], v[48:63]
    v_mfma_f32_32x32x16_bf16 v[64:79], v[136:139], v[120:123], v[64:79]
    v_mfma_f32_32x32x16_bf16 v[80:95], v[140:143], v[120:123], v[80:95]
    s_waitcnt vmcnt(0)
    s_barrier
    s_add_u32 m0, s29, 57344
    s_nop 0
    buffer_load_dwordx4 v162, s[12:15], s31 offen lds
    s_add_u32 m0, s29, 58368
    s_nop 0
    buffer_load_dwordx4 v163, s[12:15], s31 offen lds
    s_add_u32 m0, s29, 59392
    s_nop 0
    buffer_load_dwordx4 v164, s[12:15], s31 offen lds
    s_add_u32 m0, s29, 60416
    s_nop 0
    buffer_load_dwordx4 v165, s[12:15], s31 offen lds
    s_add_u32 m0, s30, 57344
    s_nop 0
    buffer_load_dwordx4 v166, s[16:19], s32 offen lds
    s_add_u32 m0, s30, 58368
    s_nop 0
    buffer_load_dwordx4 v167, s[16:19], s32 offen lds
    s_add_u32 m0, s30, 59392
    s_nop 0
    buffer_load_dwordx4 v168, s[16:19], s32 offen lds
    s_add_u32 s31, s31, 61440
    s_add_u32 s32, s32, 81920
    ds_read_b128 v[96:99], v144 offset:0
    ds_read_b64_tr_b16 v[100:101], v152 offset:0
    ds_read_b64_tr_b16 v[102:103], v152 offset:1280
    ds_read_b64_tr_b16 v[104:105], v153 offset:0
    ds_read_b64_tr_b16 v[106:107], v153 offset:1280
    ds_read_b64_tr_b16 v[108:109], v154 offset:0
    ds_read_b64_tr_b16 v[110:111], v154 offset:1280
    ds_read_b64_tr_b16 v[112:113], v155 offset:0
    ds_read_b64_tr_b16 v[114:115], v155 offset:1280
    ds_read_b64_tr_b16 v[116:117], v156 offset:0
    ds_read_b64_tr_b16 v[118:119], v156 offset:1280
    ds_read_b128 v[120:123], v145 offset:0
    ds_read_b64_tr_b16 v[124:125], v152 offset:5120
    ds_read_b64_tr_b16 v[126:127], v152 offset:6400
    ds_read_b64_tr_b16 v[128:129], v153 offset:5120
    ds_read_b64_tr_b16 v[130:131], v153 offset:6400
    ds_read_b64_tr_b16 v[132:133], v154 offset:5120
    ds_read_b64_tr_b16 v[134:135], v154 offset:6400
    ds_read_b64_tr_b16 v[136:137], v155 offset:5120
    ds_read_b64_tr_b16 v[138:139], v155 offset:6400
    ds_read_b64_tr_b16 v[140:141], v156 offset:5120
    ds_read_b64_tr_b16 v[142:143], v156 offset:6400
    s_waitcnt lgkmcnt(11)
    v_mfma_f32_32x32x16_bf16 v[16:31], v[100:103], v[96:99], v[16:31]
    v_mfma_f32_32x32x16_bf16 v[32:47], v[104:107], v[96:99], v[32:47]
    v_mfma_f32_32x32x16_bf16 v[48:63], v[108:111], v[96:99], v[48:63]
    v_mfma_f32_32x32x16_bf16 v[64:79], v[112:115], v[96:99], v[64:79]
    v_mfma_f32_32x32x16_bf16 v[80:95], v[116:119], v[96:99], v[80:95]
    ds_read_b128 v[96:99], v146 offset:0
    ds_read_b64_tr_b16 v[100:101], v152 offset:10240
    ds_read_b64_tr_b16 v[102:103], v152 offset:11520
    ds_read_b64_tr_b16 v[104:105], v153 offset:10240
    ds_read_b64_tr_b16 v[106:107], v153 offset:11520
    ds_read_b64_tr_b16 v[108:109], v154 offset:10240
    ds_read_b64_tr_b16 v[110:111], v154 offset:11520
    ds_read_b64_tr_b16 v[112:113], v155 offset:10240
    ds_read_b64_tr_b16 v[114:115], v155 offset:11520
    ds_read_b64_tr_b16 v[116:117], v156 offset:10240
    ds_read_b64_tr_b16 v[118:119], v156 offset:11520
    s_waitcnt lgkmcnt(11)
    v_mfma_f32_32x32x16_bf16 v[16:31], v[124:127], v[120:123], v[16:31]
    v_mfma_f32_32x32x16_bf16 v[32:47], v[128:131], v[120:123], v[32:47]
    v_mfma_f32_32x32x16_bf16 v[48:63], v[132:135], v[120:123], v[48:63]
    v_mfma_f32_32x32x16_bf16 v[64:79], v[136:139], v[120:123], v[64:79]
    v_mfma_f32_32x32x16_bf16 v[80:95], v[140:143], v[120:123], v[80:95]
    ds_read_b128 v[120:123], v147 offset:0
    ds_read_b64_tr_b16 v[124:125], v152 offset:15360
    ds_read_b64_tr_b16 v[126:127], v152 offset:16640
    ds_read_b64_tr_b16 v[128:129], v153 offset:15360
    ds_read_b64_tr_b16 v[130:131], v153 offset:16640
    ds_read_b64_tr_b16 v[132:133], v154 offset:15360
    ds_read_b64_tr_b16 v[134:135], v154 offset:16640
    ds_read_b64_tr_b16 v[136:137], v155 offset:15360
    ds_read_b64_tr_b16 v[138:139], v155 offset:16640
    ds_read_b64_tr_b16 v[140:141], v156 offset:15360
    ds_read_b64_tr_b16 v[142:143], v156 offset:16640
    s_waitcnt lgkmcnt(11)
    v_mfma_f32_32x32x16_bf16 v[16:31], v[100:103], v[96:99], v[16:31]
    v_mfma_f32_32x32x16_bf16 v[32:47], v[104:107], v[96:99], v[32:47]
    v_mfma_f32_32x32x16_bf16 v[48:63], v[108:111], v[96:99], v[48:63]
    v_mfma_f32_32x32x16_bf16 v[64:79], v[112:115], v[96:99], v[64:79]
    v_mfma_f32_32x32x16_bf16 v[80:95], v[116:119], v[96:99], v[80:95]
    s_waitcnt lgkmcnt(0)
    v_mfma_f32_32x32x16_bf16 v[16:31], v[124:127], v[120:123], v[16:31]
    v_mfma_f32_32x32x16_bf16 v[32:47], v[128:131], v[120:123], v[32:47]
    v_mfma_f32_32x32x16_bf16 v[48:63], v[132:135], v[120:123], v[48:63]
    v_mfma_f32_32x32x16_bf16 v[64:79], v[136:139], v[120:123], v[64:79]
    v_mfma_f32_32x32x16_bf16 v[80:95], v[140:143], v[120:123], v[80:95]
    s_waitcnt vmcnt(0)
    s_barrier
    s_add_u32 m0, s29, 0
    s_nop 0
    buffer_load_dwordx4 v162, s[12:15], s31 offen lds
    s_add_u32 m0, s29, 1024
    s_nop 0
    buffer_load_dwordx4 v163, s[12:15], s31 offen lds
    s_add_u32 m0, s29, 2048
    s_nop 0
    buffer_load_dwordx4 v164, s[12:15], s31 offen lds
    s_add_u32 m0, s29, 3072
    s_nop 0
    buffer_load_dwordx4 v165, s[12:15], s31 offen lds
    s_add_u32 m0, s30, 0
    s_nop 0
    buffer_load_dwordx4 v166, s[16:19], s32 offen lds
    s_add_u32 m0, s30, 1024
    s_nop 0
    buffer_load_dwordx4 v167, s[16:19], s32 offen lds
    s_add_u32 m0, s30, 2048
    s_nop 0
    buffer_load_dwordx4 v168, s[16:19], s32 offen lds
    s_add_u32 s31, s31, 4096
    s_add_u32 s32, s32, 81920
    ds_read_b128 v[96:99], v148 offset:0
    ds_read_b64_tr_b16 v[100:101], v157 offset:0
    ds_read_b64_tr_b16 v[102:103], v157 offset:1280
    ds_read_b64_tr_b16 v[104:105], v158 offset:0
    ds_read_b64_tr_b16 v[106:107], v158 offset:1280
    ds_read_b64_tr_b16 v[108:109], v159 offset:0
    ds_read_b64_tr_b16 v[110:111], v159 offset:1280
    ds_read_b64_tr_b16 v[112:113], v160 offset:0
    ds_read_b64_tr_b16 v[114:115], v160 offset:1280
    ds_read_b64_tr_b16 v[116:117], v161 offset:0
    ds_read_b64_tr_b16 v[118:119], v161 offset:1280
    ds_read_b128 v[120:123], v149 offset:0
    ds_read_b64_tr_b16 v[124:125], v157 offset:5120
    ds_read_b64_tr_b16 v[126:127], v157 offset:6400
    ds_read_b64_tr_b16 v[128:129], v158 offset:5120
    ds_read_b64_tr_b16 v[130:131], v158 offset:6400
    ds_read_b64_tr_b16 v[132:133], v159 offset:5120
    ds_read_b64_tr_b16 v[134:135], v159 offset:6400
    ds_read_b64_tr_b16 v[136:137], v160 offset:5120
    ds_read_b64_tr_b16 v[138:139], v160 offset:6400
    ds_read_b64_tr_b16 v[140:141], v161 offset:5120
    ds_read_b64_tr_b16 v[142:143], v161 offset:6400
    s_waitcnt lgkmcnt(11)
    v_mfma_f32_32x32x16_bf16 v[16:31], v[100:103], v[96:99], v[16:31]
    v_mfma_f32_32x32x16_bf16 v[32:47], v[104:107], v[96:99], v[32:47]
    v_mfma_f32_32x32x16_bf16 v[48:63], v[108:111], v[96:99], v[48:63]
    v_mfma_f32_32x32x16_bf16 v[64:79], v[112:115], v[96:99], v[64:79]
    v_mfma_f32_32x32x16_bf16 v[80:95], v[116:119], v[96:99], v[80:95]
    ds_read_b128 v[96:99], v150 offset:0
    ds_read_b64_tr_b16 v[100:101], v157 offset:10240
    ds_read_b64_tr_b16 v[102:103], v157 offset:11520
    ds_read_b64_tr_b16 v[104:105], v158 offset:10240
    ds_read_b64_tr_b16 v[106:107], v158 offset:11520
    ds_read_b64_tr_b16 v[108:109], v159 offset:10240
    ds_read_b64_tr_b16 v[110:111], v159 offset:11520
    ds_read_b64_tr_b16 v[112:113], v160 offset:10240
    ds_read_b64_tr_b16 v[114:115], v160 offset:11520
    ds_read_b64_tr_b16 v[116:117], v161 offset:10240
    ds_read_b64_tr_b16 v[118:119], v161 offset:11520
    s_waitcnt lgkmcnt(11)
    v_mfma_f32_32x32x16_bf16 v[16:31], v[124:127], v[120:123], v[16:31]
    v_mfma_f32_32x32x16_bf16 v[32:47], v[128:131], v[120:123], v[32:47]
    v_mfma_f32_32x32x16_bf16 v[48:63], v[132:135], v[120:123], v[48:63]
    v_mfma_f32_32x32x16_bf16 v[64:79], v[136:139], v[120:123], v[64:79]
    v_mfma_f32_32x32x16_bf16 v[80:95], v[140:143], v[120:123], v[80:95]
    ds_read_b128 v[120:123], v151 offset:0
    ds_read_b64_tr_b16 v[124:125], v157 offset:15360
    ds_read_b64_tr_b16 v[126:127], v157 offset:16640
    ds_read_b64_tr_b16 v[128:129], v158 offset:15360
    ds_read_b64_tr_b16 v[130:131], v158 offset:16640
    ds_read_b64_tr_b16 v[132:133], v159 offset:15360
    ds_read_b64_tr_b16 v[134:135], v159 offset:16640
    ds_read_b64_tr_b16 v[136:137], v160 offset:15360
    ds_read_b64_tr_b16 v[138:139], v160 offset:16640
    ds_read_b64_tr_b16 v[140:141], v161 offset:15360
    ds_read_b64_tr_b16 v[142:143], v161 offset:16640
    s_waitcnt lgkmcnt(11)
    v_mfma_f32_32x32x16_bf16 v[16:31], v[100:103], v[96:99], v[16:31]
    v_mfma_f32_32x32x16_bf16 v[32:47], v[104:107], v[96:99], v[32:47]
    v_mfma_f32_32x32x16_bf16 v[48:63], v[108:111], v[96:99], v[48:63]
    v_mfma_f32_32x32x16_bf16 v[64:79], v[112:115], v[96:99], v[64:79]
    v_mfma_f32_32x32x16_bf16 v[80:95], v[116:119], v[96:99], v[80:95]
    s_waitcnt lgkmcnt(0)
    v_mfma_f32_32x32x16_bf16 v[16:31], v[124:127], v[120:123], v[16:31]
    v_mfma_f32_32x32x16_bf16 v[32:47], v[128:131], v[120:123], v[32:47]
    v_mfma_f32_32x32x16_bf16 v[48:63], v[132:135], v[120:123], v[48:63]
    v_mfma_f32_32x32x16_bf16 v[64:79], v[136:139], v[120:123], v[64:79]
    v_mfma_f32_32x32x16_bf16 v[80:95], v[140:143], v[120:123], v[80:95]
    s_waitcnt vmcnt(0)
    s_barrier
    s_add_u32 m0, s29, 57344
    s_nop 0
    buffer_load_dwordx4 v162, s[12:15], s31 offen lds
    s_add_u32 m0, s29, 58368
    s_nop 0
    buffer_load_dwordx4 v163, s[12:15], s31 offen lds
    s_add_u32 m0, s29, 59392
    s_nop 0
    buffer_load_dwordx4 v164, s[12:15], s31 offen lds
    s_add_u32 m0, s29, 60416
    s_nop 0
    buffer_load_dwordx4 v165, s[12:15], s31 offen lds
    s_add_u32 m0, s30, 57344
    s_nop 0
    buffer_load_dwordx4 v166, s[16:19], s32 offen lds
    s_add_u32 m0, s30, 58368
    s_nop 0
    buffer_load_dwordx4 v167, s[16:19], s32 offen lds
    s_add_u32 m0, s30, 59392
    s_nop 0
    buffer_load_dwordx4 v168, s[16:19], s32 offen lds
    s_add_u32 s31, s31, 61440
    s_add_u32 s32, s32, 81920
    ds_read_b128 v[96:99], v144 offset:0
    ds_read_b64_tr_b16 v[100:101], v152 offset:0
    ds_read_b64_tr_b16 v[102:103], v152 offset:1280
    ds_read_b64_tr_b16 v[104:105], v153 offset:0
    ds_read_b64_tr_b16 v[106:107], v153 offset:1280
    ds_read_b64_tr_b16 v[108:109], v154 offset:0
    ds_read_b64_tr_b16 v[110:111], v154 offset:1280
    ds_read_b64_tr_b16 v[112:113], v155 offset:0
    ds_read_b64_tr_b16 v[114:115], v155 offset:1280
    ds_read_b64_tr_b16 v[116:117], v156 offset:0
    ds_read_b64_tr_b16 v[118:119], v156 offset:1280
    ds_read_b128 v[120:123], v145 offset:0
    ds_read_b64_tr_b16 v[124:125], v152 offset:5120
    ds_read_b64_tr_b16 v[126:127], v152 offset:6400
    ds_read_b64_tr_b16 v[128:129], v153 offset:5120
    ds_read_b64_tr_b16 v[130:131], v153 offset:6400
    ds_read_b64_tr_b16 v[132:133], v154 offset:5120
    ds_read_b64_tr_b16 v[134:135], v154 offset:6400
    ds_read_b64_tr_b16 v[136:137], v155 offset:5120
    ds_read_b64_tr_b16 v[138:139], v155 offset:6400
    ds_read_b64_tr_b16 v[140:141], v156 offset:5120
    ds_read_b64_tr_b16 v[142:143], v156 offset:6400
    s_waitcnt lgkmcnt(11)
    v_mfma_f32_32x32x16_bf16 v[16:31], v[100:103], v[96:99], v[16:31]
    v_mfma_f32_32x32x16_bf16 v[32:47], v[104:107], v[96:99], v[32:47]
    v_mfma_f32_32x32x16_bf16 v[48:63], v[108:111], v[96:99], v[48:63]
    v_mfma_f32_32x32x16_bf16 v[64:79], v[112:115], v[96:99], v[64:79]
    v_mfma_f32_32x32x16_bf16 v[80:95], v[116:119], v[96:99], v[80:95]
    ds_read_b128 v[96:99], v146 offset:0
    ds_read_b64_tr_b16 v[100:101], v152 offset:10240
    ds_read_b64_tr_b16 v[102:103], v152 offset:11520
    ds_read_b64_tr_b16 v[104:105], v153 offset:10240
    ds_read_b64_tr_b16 v[106:107], v153 offset:11520
    ds_read_b64_tr_b16 v[108:109], v154 offset:10240
    ds_read_b64_tr_b16 v[110:111], v154 offset:11520
    ds_read_b64_tr_b16 v[112:113], v155 offset:10240
    ds_read_b64_tr_b16 v[114:115], v155 offset:11520
    ds_read_b64_tr_b16 v[116:117], v156 offset:10240
    ds_read_b64_tr_b16 v[118:119], v156 offset:11520
    s_waitcnt lgkmcnt(11)
    v_mfma_f32_32x32x16_bf16 v[16:31], v[124:127], v[120:123], v[16:31]
    v_mfma_f32_32x32x16_bf16 v[32:47], v[128:131], v[120:123], v[32:47]
    v_mfma_f32_32x32x16_bf16 v[48:63], v[132:135], v[120:123], v[48:63]
    v_mfma_f32_32x32x16_bf16 v[64:79], v[136:139], v[120:123], v[64:79]
    v_mfma_f32_32x32x16_bf16 v[80:95], v[140:143], v[120:123], v[80:95]
    ds_read_b128 v[120:123], v147 offset:0
    ds_read_b64_tr_b16 v[124:125], v152 offset:15360
    ds_read_b64_tr_b16 v[126:127], v152 offset:16640
    ds_read_b64_tr_b16 v[128:129], v153 offset:15360
    ds_read_b64_tr_b16 v[130:131], v153 offset:16640
    ds_read_b64_tr_b16 v[132:133], v154 offset:15360
    ds_read_b64_tr_b16 v[134:135], v154 offset:16640
    ds_read_b64_tr_b16 v[136:137], v155 offset:15360
    ds_read_b64_tr_b16 v[138:139], v155 offset:16640
    ds_read_b64_tr_b16 v[140:141], v156 offset:15360
    ds_read_b64_tr_b16 v[142:143], v156 offset:16640
    s_waitcnt lgkmcnt(11)
    v_mfma_f32_32x32x16_bf16 v[16:31], v[100:103], v[96:99], v[16:31]
    v_mfma_f32_32x32x16_bf16 v[32:47], v[104:107], v[96:99], v[32:47]
    v_mfma_f32_32x32x16_bf16 v[48:63], v[108:111], v[96:99], v[48:63]
    v_mfma_f32_32x32x16_bf16 v[64:79], v[112:115], v[96:99], v[64:79]
    v_mfma_f32_32x32x16_bf16 v[80:95], v[116:119], v[96:99], v[80:95]
    s_waitcnt lgkmcnt(0)
    v_mfma_f32_32x32x16_bf16 v[16:31], v[124:127], v[120:123], v[16:31]
    v_mfma_f32_32x32x16_bf16 v[32:47], v[128:131], v[120:123], v[32:47]
    v_mfma_f32_32x32x16_bf16 v[48:63], v[132:135], v[120:123], v[48:63]
    v_mfma_f32_32x32x16_bf16 v[64:79], v[136:139], v[120:123], v[64:79]
    v_mfma_f32_32x32x16_bf16 v[80:95], v[140:143], v[120:123], v[80:95]
    s_waitcnt vmcnt(0)
    s_barrier
    s_add_u32 m0, s29, 0
    s_nop 0
    buffer_load_dwordx4 v162, s[12:15], s31 offen lds
    s_add_u32 m0, s29, 1024
    s_nop 0
    buffer_load_dwordx4 v163, s[12:15], s31 offen lds
    s_add_u32 m0, s29, 2048
    s_nop 0
    buffer_load_dwordx4 v164, s[12:15], s31 offen lds
    s_add_u32 m0, s29, 3072
    s_nop 0
    buffer_load_dwordx4 v165, s[12:15], s31 offen lds
    s_add_u32 m0, s30, 0
    s_nop 0
    buffer_load_dwordx4 v166, s[16:19], s32 offen lds
    s_add_u32 m0, s30, 1024
    s_nop 0
    buffer_load_dwordx4 v167, s[16:19], s32 offen lds
    s_add_u32 m0, s30, 2048
    s_nop 0
    buffer_load_dwordx4 v168, s[16:19], s32 offen lds
    s_add_u32 s31, s31, 4096
    s_add_u32 s32, s32, 81920
    ds_read_b128 v[96:99], v148 offset:0
    ds_read_b64_tr_b16 v[100:101], v157 offset:0
    ds_read_b64_tr_b16 v[102:103], v157 offset:1280
    ds_read_b64_tr_b16 v[104:105], v158 offset:0
    ds_read_b64_tr_b16 v[106:107], v158 offset:1280
    ds_read_b64_tr_b16 v[108:109], v159 offset:0
    ds_read_b64_tr_b16 v[110:111], v159 offset:1280
    ds_read_b64_tr_b16 v[112:113], v160 offset:0
    ds_read_b64_tr_b16 v[114:115], v160 offset:1280
    ds_read_b64_tr_b16 v[116:117], v161 offset:0
    ds_read_b64_tr_b16 v[118:119], v161 offset:1280
    ds_read_b128 v[120:123], v149 offset:0
    ds_read_b64_tr_b16 v[124:125], v157 offset:5120
    ds_read_b64_tr_b16 v[126:127], v157 offset:6400
    ds_read_b64_tr_b16 v[128:129], v158 offset:5120
    ds_read_b64_tr_b16 v[130:131], v158 offset:6400
    ds_read_b64_tr_b16 v[132:133], v159 offset:5120
    ds_read_b64_tr_b16 v[134:135], v159 offset:6400
    ds_read_b64_tr_b16 v[136:137], v160 offset:5120
    ds_read_b64_tr_b16 v[138:139], v160 offset:6400
    ds_read_b64_tr_b16 v[140:141], v161 offset:5120
    ds_read_b64_tr_b16 v[142:143], v161 offset:6400
    s_waitcnt lgkmcnt(11)
    v_mfma_f32_32x32x16_bf16 v[16:31], v[100:103], v[96:99], v[16:31]
    v_mfma_f32_32x32x16_bf16 v[32:47], v[104:107], v[96:99], v[32:47]
    v_mfma_f32_32x32x16_bf16 v[48:63], v[108:111], v[96:99], v[48:63]
    v_mfma_f32_32x32x16_bf16 v[64:79], v[112:115], v[96:99], v[64:79]
    v_mfma_f32_32x32x16_bf16 v[80:95], v[116:119], v[96:99], v[80:95]
    ds_read_b128 v[96:99], v150 offset:0
    ds_read_b64_tr_b16 v[100:101], v157 offset:10240
    ds_read_b64_tr_b16 v[102:103], v157 offset:11520
    ds_read_b64_tr_b16 v[104:105], v158 offset:10240
    ds_read_b64_tr_b16 v[106:107], v158 offset:11520
    ds_read_b64_tr_b16 v[108:109], v159 offset:10240
    ds_read_b64_tr_b16 v[110:111], v159 offset:11520
    ds_read_b64_tr_b16 v[112:113], v160 offset:10240
    ds_read_b64_tr_b16 v[114:115], v160 offset:11520
    ds_read_b64_tr_b16 v[116:117], v161 offset:10240
    ds_read_b64_tr_b16 v[118:119], v161 offset:11520
    s_waitcnt lgkmcnt(11)
    v_mfma_f32_32x32x16_bf16 v[16:31], v[124:127], v[120:123], v[16:31]
    v_mfma_f32_32x32x16_bf16 v[32:47], v[128:131], v[120:123], v[32:47]
    v_mfma_f32_32x32x16_bf16 v[48:63], v[132:135], v[120:123], v[48:63]
    v_mfma_f32_32x32x16_bf16 v[64:79], v[136:139], v[120:123], v[64:79]
    v_mfma_f32_32x32x16_bf16 v[80:95], v[140:143], v[120:123], v[80:95]
    ds_read_b128 v[120:123], v151 offset:0
    ds_read_b64_tr_b16 v[124:125], v157 offset:15360
    ds_read_b64_tr_b16 v[126:127], v157 offset:16640
    ds_read_b64_tr_b16 v[128:129], v158 offset:15360
    ds_read_b64_tr_b16 v[130:131], v158 offset:16640
    ds_read_b64_tr_b16 v[132:133], v159 offset:15360
    ds_read_b64_tr_b16 v[134:135], v159 offset:16640
    ds_read_b64_tr_b16 v[136:137], v160 offset:15360
    ds_read_b64_tr_b16 v[138:139], v160 offset:16640
    ds_read_b64_tr_b16 v[140:141], v161 offset:15360
    ds_read_b64_tr_b16 v[142:143], v161 offset:16640
    s_waitcnt lgkmcnt(11)
    v_mfma_f32_32x32x16_bf16 v[16:31], v[100:103], v[96:99], v[16:31]
    v_mfma_f32_32x32x16_bf16 v[32:47], v[104:107], v[96:99], v[32:47]
    v_mfma_f32_32x32x16_bf16 v[48:63], v[108:111], v[96:99], v[48:63]
    v_mfma_f32_32x32x16_bf16 v[64:79], v[112:115], v[96:99], v[64:79]
    v_mfma_f32_32x32x16_bf16 v[80:95], v[116:119], v[96:99], v[80:95]
    s_waitcnt lgkmcnt(0)
    v_mfma_f32_32x32x16_bf16 v[16:31], v[124:127], v[120:123], v[16:31]
    v_mfma_f32_32x32x16_bf16 v[32:47], v[128:131], v[120:123], v[32:47]
    v_mfma_f32_32x32x16_bf16 v[48:63], v[132:135], v[120:123], v[48:63]
    v_mfma_f32_32x32x16_bf16 v[64:79], v[136:139], v[120:123], v[64:79]
    v_mfma_f32_32x32x16_bf16 v[80:95], v[140:143], v[120:123], v[80:95]
    s_waitcnt vmcnt(0)
    s_barrier
    s_add_u32 m0, s29, 57344
    s_nop 0
    buffer_load_dwordx4 v162, s[12:15], s31 offen lds
    s_add_u32 m0, s29, 58368
    s_nop 0
    buffer_load_dwordx4 v163, s[12:15], s31 offen lds
    s_add_u32 m0, s29, 59392
    s_nop 0
    buffer_load_dwordx4 v164, s[12:15], s31 offen lds
    s_add_u32 m0, s29, 60416
    s_nop 0
    buffer_load_dwordx4 v165, s[12:15], s31 offen lds
    s_add_u32 m0, s30, 57344
    s_nop 0
    buffer_load_dwordx4 v166, s[16:19], s32 offen lds
    s_add_u32 m0, s30, 58368
    s_nop 0
    buffer_load_dwordx4 v167, s[16:19], s32 offen lds
    s_add_u32 m0, s30, 59392
    s_nop 0
    buffer_load_dwordx4 v168, s[16:19], s32 offen lds
    s_add_u32 s31, s31, 61440
    s_add_u32 s32, s32, 81920
    ds_read_b128 v[96:99], v144 offset:0
    ds_read_b64_tr_b16 v[100:101], v152 offset:0
    ds_read_b64_tr_b16 v[102:103], v152 offset:1280
    ds_read_b64_tr_b16 v[104:105], v153 offset:0
    ds_read_b64_tr_b16 v[106:107], v153 offset:1280
    ds_read_b64_tr_b16 v[108:109], v154 offset:0
    ds_read_b64_tr_b16 v[110:111], v154 offset:1280
    ds_read_b64_tr_b16 v[112:113], v155 offset:0
    ds_read_b64_tr_b16 v[114:115], v155 offset:1280
    ds_read_b64_tr_b16 v[116:117], v156 offset:0
    ds_read_b64_tr_b16 v[118:119], v156 offset:1280
    ds_read_b128 v[120:123], v145 offset:0
    ds_read_b64_tr_b16 v[124:125], v152 offset:5120
    ds_read_b64_tr_b16 v[126:127], v152 offset:6400
    ds_read_b64_tr_b16 v[128:129], v153 offset:5120
    ds_read_b64_tr_b16 v[130:131], v153 offset:6400
    ds_read_b64_tr_b16 v[132:133], v154 offset:5120
    ds_read_b64_tr_b16 v[134:135], v154 offset:6400
    ds_read_b64_tr_b16 v[136:137], v155 offset:5120
    ds_read_b64_tr_b16 v[138:139], v155 offset:6400
    ds_read_b64_tr_b16 v[140:141], v156 offset:5120
    ds_read_b64_tr_b16 v[142:143], v156 offset:6400
    s_waitcnt lgkmcnt(11)
    v_mfma_f32_32x32x16_bf16 v[16:31], v[100:103], v[96:99], v[16:31]
    v_mfma_f32_32x32x16_bf16 v[32:47], v[104:107], v[96:99], v[32:47]
    v_mfma_f32_32x32x16_bf16 v[48:63], v[108:111], v[96:99], v[48:63]
    v_mfma_f32_32x32x16_bf16 v[64:79], v[112:115], v[96:99], v[64:79]
    v_mfma_f32_32x32x16_bf16 v[80:95], v[116:119], v[96:99], v[80:95]
    ds_read_b128 v[96:99], v146 offset:0
    ds_read_b64_tr_b16 v[100:101], v152 offset:10240
    ds_read_b64_tr_b16 v[102:103], v152 offset:11520
    ds_read_b64_tr_b16 v[104:105], v153 offset:10240
    ds_read_b64_tr_b16 v[106:107], v153 offset:11520
    ds_read_b64_tr_b16 v[108:109], v154 offset:10240
    ds_read_b64_tr_b16 v[110:111], v154 offset:11520
    ds_read_b64_tr_b16 v[112:113], v155 offset:10240
    ds_read_b64_tr_b16 v[114:115], v155 offset:11520
    ds_read_b64_tr_b16 v[116:117], v156 offset:10240
    ds_read_b64_tr_b16 v[118:119], v156 offset:11520
    s_waitcnt lgkmcnt(11)
    v_mfma_f32_32x32x16_bf16 v[16:31], v[124:127], v[120:123], v[16:31]
    v_mfma_f32_32x32x16_bf16 v[32:47], v[128:131], v[120:123], v[32:47]
    v_mfma_f32_32x32x16_bf16 v[48:63], v[132:135], v[120:123], v[48:63]
    v_mfma_f32_32x32x16_bf16 v[64:79], v[136:139], v[120:123], v[64:79]
    v_mfma_f32_32x32x16_bf16 v[80:95], v[140:143], v[120:123], v[80:95]
    ds_read_b128 v[120:123], v147 offset:0
    ds_read_b64_tr_b16 v[124:125], v152 offset:15360
    ds_read_b64_tr_b16 v[126:127], v152 offset:16640
    ds_read_b64_tr_b16 v[128:129], v153 offset:15360
    ds_read_b64_tr_b16 v[130:131], v153 offset:16640
    ds_read_b64_tr_b16 v[132:133], v154 offset:15360
    ds_read_b64_tr_b16 v[134:135], v154 offset:16640
    ds_read_b64_tr_b16 v[136:137], v155 offset:15360
    ds_read_b64_tr_b16 v[138:139], v155 offset:16640
    ds_read_b64_tr_b16 v[140:141], v156 offset:15360
    ds_read_b64_tr_b16 v[142:143], v156 offset:16640
    s_waitcnt lgkmcnt(11)
    v_mfma_f32_32x32x16_bf16 v[16:31], v[100:103], v[96:99], v[16:31]
    v_mfma_f32_32x32x16_bf16 v[32:47], v[104:107], v[96:99], v[32:47]
    v_mfma_f32_32x32x16_bf16 v[48:63], v[108:111], v[96:99], v[48:63]
    v_mfma_f32_32x32x16_bf16 v[64:79], v[112:115], v[96:99], v[64:79]
    v_mfma_f32_32x32x16_bf16 v[80:95], v[116:119], v[96:99], v[80:95]
    s_waitcnt lgkmcnt(0)
    v_mfma_f32_32x32x16_bf16 v[16:31], v[124:127], v[120:123], v[16:31]
    v_mfma_f32_32x32x16_bf16 v[32:47], v[128:131], v[120:123], v[32:47]
    v_mfma_f32_32x32x16_bf16 v[48:63], v[132:135], v[120:123], v[48:63]
    v_mfma_f32_32x32x16_bf16 v[64:79], v[136:139], v[120:123], v[64:79]
    v_mfma_f32_32x32x16_bf16 v[80:95], v[140:143], v[120:123], v[80:95]
    s_waitcnt vmcnt(0)
    s_barrier
    s_add_u32 m0, s29, 0
    s_nop 0
    buffer_load_dwordx4 v162, s[12:15], s31 offen lds
    s_add_u32 m0, s29, 1024
    s_nop 0
    buffer_load_dwordx4 v163, s[12:15], s31 offen lds
    s_add_u32 m0, s29, 2048
    s_nop 0
    buffer_load_dwordx4 v164, s[12:15], s31 offen lds
    s_add_u32 m0, s29, 3072
    s_nop 0
    buffer_load_dwordx4 v165, s[12:15], s31 offen lds
    s_add_u32 m0, s30, 0
    s_nop 0
    buffer_load_dwordx4 v166, s[16:19], s32 offen lds
    s_add_u32 m0, s30, 1024
    s_nop 0
    buffer_load_dwordx4 v167, s[16:19], s32 offen lds
    s_add_u32 m0, s30, 2048
    s_nop 0
    buffer_load_dwordx4 v168, s[16:19], s32 offen lds
    s_add_u32 s31, s31, 4096
    s_add_u32 s32, s32, 81920
    ds_read_b128 v[96:99], v148 offset:0
    ds_read_b64_tr_b16 v[100:101], v157 offset:0
    ds_read_b64_tr_b16 v[102:103], v157 offset:1280
    ds_read_b64_tr_b16 v[104:105], v158 offset:0
    ds_read_b64_tr_b16 v[106:107], v158 offset:1280
    ds_read_b64_tr_b16 v[108:109], v159 offset:0
    ds_read_b64_tr_b16 v[110:111], v159 offset:1280
    ds_read_b64_tr_b16 v[112:113], v160 offset:0
    ds_read_b64_tr_b16 v[114:115], v160 offset:1280
    ds_read_b64_tr_b16 v[116:117], v161 offset:0
    ds_read_b64_tr_b16 v[118:119], v161 offset:1280
    ds_read_b128 v[120:123], v149 offset:0
    ds_read_b64_tr_b16 v[124:125], v157 offset:5120
    ds_read_b64_tr_b16 v[126:127], v157 offset:6400
    ds_read_b64_tr_b16 v[128:129], v158 offset:5120
    ds_read_b64_tr_b16 v[130:131], v158 offset:6400
    ds_read_b64_tr_b16 v[132:133], v159 offset:5120
    ds_read_b64_tr_b16 v[134:135], v159 offset:6400
    ds_read_b64_tr_b16 v[136:137], v160 offset:5120
    ds_read_b64_tr_b16 v[138:139], v160 offset:6400
    ds_read_b64_tr_b16 v[140:141], v161 offset:5120
    ds_read_b64_tr_b16 v[142:143], v161 offset:6400
    s_waitcnt lgkmcnt(11)
    v_mfma_f32_32x32x16_bf16 v[16:31], v[100:103], v[96:99], v[16:31]
    v_mfma_f32_32x32x16_bf16 v[32:47], v[104:107], v[96:99], v[32:47]
    v_mfma_f32_32x32x16_bf16 v[48:63], v[108:111], v[96:99], v[48:63]
    v_mfma_f32_32x32x16_bf16 v[64:79], v[112:115], v[96:99], v[64:79]
    v_mfma_f32_32x32x16_bf16 v[80:95], v[116:119], v[96:99], v[80:95]
    ds_read_b128 v[96:99], v150 offset:0
    ds_read_b64_tr_b16 v[100:101], v157 offset:10240
    ds_read_b64_tr_b16 v[102:103], v157 offset:11520
    ds_read_b64_tr_b16 v[104:105], v158 offset:10240
    ds_read_b64_tr_b16 v[106:107], v158 offset:11520
    ds_read_b64_tr_b16 v[108:109], v159 offset:10240
    ds_read_b64_tr_b16 v[110:111], v159 offset:11520
    ds_read_b64_tr_b16 v[112:113], v160 offset:10240
    ds_read_b64_tr_b16 v[114:115], v160 offset:11520
    ds_read_b64_tr_b16 v[116:117], v161 offset:10240
    ds_read_b64_tr_b16 v[118:119], v161 offset:11520
    s_waitcnt lgkmcnt(11)
    v_mfma_f32_32x32x16_bf16 v[16:31], v[124:127], v[120:123], v[16:31]
    v_mfma_f32_32x32x16_bf16 v[32:47], v[128:131], v[120:123], v[32:47]
    v_mfma_f32_32x32x16_bf16 v[48:63], v[132:135], v[120:123], v[48:63]
    v_mfma_f32_32x32x16_bf16 v[64:79], v[136:139], v[120:123], v[64:79]
    v_mfma_f32_32x32x16_bf16 v[80:95], v[140:143], v[120:123], v[80:95]
    ds_read_b128 v[120:123], v151 offset:0
    ds_read_b64_tr_b16 v[124:125], v157 offset:15360
    ds_read_b64_tr_b16 v[126:127], v157 offset:16640
    ds_read_b64_tr_b16 v[128:129], v158 offset:15360
    ds_read_b64_tr_b16 v[130:131], v158 offset:16640
    ds_read_b64_tr_b16 v[132:133], v159 offset:15360
    ds_read_b64_tr_b16 v[134:135], v159 offset:16640
    ds_read_b64_tr_b16 v[136:137], v160 offset:15360
    ds_read_b64_tr_b16 v[138:139], v160 offset:16640
    ds_read_b64_tr_b16 v[140:141], v161 offset:15360
    ds_read_b64_tr_b16 v[142:143], v161 offset:16640
    s_waitcnt lgkmcnt(11)
    v_mfma_f32_32x32x16_bf16 v[16:31], v[100:103], v[96:99], v[16:31]
    v_mfma_f32_32x32x16_bf16 v[32:47], v[104:107], v[96:99], v[32:47]
    v_mfma_f32_32x32x16_bf16 v[48:63], v[108:111], v[96:99], v[48:63]
    v_mfma_f32_32x32x16_bf16 v[64:79], v[112:115], v[96:99], v[64:79]
    v_mfma_f32_32x32x16_bf16 v[80:95], v[116:119], v[96:99], v[80:95]
    s_waitcnt lgkmcnt(0)
    v_mfma_f32_32x32x16_bf16 v[16:31], v[124:127], v[120:123], v[16:31]
    v_mfma_f32_32x32x16_bf16 v[32:47], v[128:131], v[120:123], v[32:47]
    v_mfma_f32_32x32x16_bf16 v[48:63], v[132:135], v[120:123], v[48:63]
    v_mfma_f32_32x32x16_bf16 v[64:79], v[136:139], v[120:123], v[64:79]
    v_mfma_f32_32x32x16_bf16 v[80:95], v[140:143], v[120:123], v[80:95]
    s_waitcnt vmcnt(0)
    s_barrier
    s_add_u32 m0, s29, 57344
    s_nop 0
    buffer_load_dwordx4 v162, s[12:15], s31 offen lds
    s_add_u32 m0, s29, 58368
    s_nop 0
    buffer_load_dwordx4 v163, s[12:15], s31 offen lds
    s_add_u32 m0, s29, 59392
    s_nop 0
    buffer_load_dwordx4 v164, s[12:15], s31 offen lds
    s_add_u32 m0, s29, 60416
    s_nop 0
    buffer_load_dwordx4 v165, s[12:15], s31 offen lds
    s_add_u32 m0, s30, 57344
    s_nop 0
    buffer_load_dwordx4 v166, s[16:19], s32 offen lds
    s_add_u32 m0, s30, 58368
    s_nop 0
    buffer_load_dwordx4 v167, s[16:19], s32 offen lds
    s_add_u32 m0, s30, 59392
    s_nop 0
    buffer_load_dwordx4 v168, s[16:19], s32 offen lds
    s_add_u32 s31, s31, 61440
    s_add_u32 s32, s32, 81920
    ds_read_b128 v[96:99], v144 offset:0
    ds_read_b64_tr_b16 v[100:101], v152 offset:0
    ds_read_b64_tr_b16 v[102:103], v152 offset:1280
    ds_read_b64_tr_b16 v[104:105], v153 offset:0
    ds_read_b64_tr_b16 v[106:107], v153 offset:1280
    ds_read_b64_tr_b16 v[108:109], v154 offset:0
    ds_read_b64_tr_b16 v[110:111], v154 offset:1280
    ds_read_b64_tr_b16 v[112:113], v155 offset:0
    ds_read_b64_tr_b16 v[114:115], v155 offset:1280
    ds_read_b64_tr_b16 v[116:117], v156 offset:0
    ds_read_b64_tr_b16 v[118:119], v156 offset:1280
    ds_read_b128 v[120:123], v145 offset:0
    ds_read_b64_tr_b16 v[124:125], v152 offset:5120
    ds_read_b64_tr_b16 v[126:127], v152 offset:6400
    ds_read_b64_tr_b16 v[128:129], v153 offset:5120
    ds_read_b64_tr_b16 v[130:131], v153 offset:6400
    ds_read_b64_tr_b16 v[132:133], v154 offset:5120
    ds_read_b64_tr_b16 v[134:135], v154 offset:6400
    ds_read_b64_tr_b16 v[136:137], v155 offset:5120
    ds_read_b64_tr_b16 v[138:139], v155 offset:6400
    ds_read_b64_tr_b16 v[140:141], v156 offset:5120
    ds_read_b64_tr_b16 v[142:143], v156 offset:6400
    s_waitcnt lgkmcnt(11)
    v_mfma_f32_32x32x16_bf16 v[16:31], v[100:103], v[96:99], v[16:31]
    v_mfma_f32_32x32x16_bf16 v[32:47], v[104:107], v[96:99], v[32:47]
    v_mfma_f32_32x32x16_bf16 v[48:63], v[108:111], v[96:99], v[48:63]
    v_mfma_f32_32x32x16_bf16 v[64:79], v[112:115], v[96:99], v[64:79]
    v_mfma_f32_32x32x16_bf16 v[80:95], v[116:119], v[96:99], v[80:95]
    ds_read_b128 v[96:99], v146 offset:0
    ds_read_b64_tr_b16 v[100:101], v152 offset:10240
    ds_read_b64_tr_b16 v[102:103], v152 offset:11520
    ds_read_b64_tr_b16 v[104:105], v153 offset:10240
    ds_read_b64_tr_b16 v[106:107], v153 offset:11520
    ds_read_b64_tr_b16 v[108:109], v154 offset:10240
    ds_read_b64_tr_b16 v[110:111], v154 offset:11520
    ds_read_b64_tr_b16 v[112:113], v155 offset:10240
    ds_read_b64_tr_b16 v[114:115], v155 offset:11520
    ds_read_b64_tr_b16 v[116:117], v156 offset:10240
    ds_read_b64_tr_b16 v[118:119], v156 offset:11520
    s_waitcnt lgkmcnt(11)
    v_mfma_f32_32x32x16_bf16 v[16:31], v[124:127], v[120:123], v[16:31]
    v_mfma_f32_32x32x16_bf16 v[32:47], v[128:131], v[120:123], v[32:47]
    v_mfma_f32_32x32x16_bf16 v[48:63], v[132:135], v[120:123], v[48:63]
    v_mfma_f32_32x32x16_bf16 v[64:79], v[136:139], v[120:123], v[64:79]
    v_mfma_f32_32x32x16_bf16 v[80:95], v[140:143], v[120:123], v[80:95]
    ds_read_b128 v[120:123], v147 offset:0
    ds_read_b64_tr_b16 v[124:125], v152 offset:15360
    ds_read_b64_tr_b16 v[126:127], v152 offset:16640
    ds_read_b64_tr_b16 v[128:129], v153 offset:15360
    ds_read_b64_tr_b16 v[130:131], v153 offset:16640
    ds_read_b64_tr_b16 v[132:133], v154 offset:15360
    ds_read_b64_tr_b16 v[134:135], v154 offset:16640
    ds_read_b64_tr_b16 v[136:137], v155 offset:15360
    ds_read_b64_tr_b16 v[138:139], v155 offset:16640
    ds_read_b64_tr_b16 v[140:141], v156 offset:15360
    ds_read_b64_tr_b16 v[142:143], v156 offset:16640
    s_waitcnt lgkmcnt(11)
    v_mfma_f32_32x32x16_bf16 v[16:31], v[100:103], v[96:99], v[16:31]
    v_mfma_f32_32x32x16_bf16 v[32:47], v[104:107], v[96:99], v[32:47]
    v_mfma_f32_32x32x16_bf16 v[48:63], v[108:111], v[96:99], v[48:63]
    v_mfma_f32_32x32x16_bf16 v[64:79], v[112:115], v[96:99], v[64:79]
    v_mfma_f32_32x32x16_bf16 v[80:95], v[116:119], v[96:99], v[80:95]
    s_waitcnt lgkmcnt(0)
    v_mfma_f32_32x32x16_bf16 v[16:31], v[124:127], v[120:123], v[16:31]
    v_mfma_f32_32x32x16_bf16 v[32:47], v[128:131], v[120:123], v[32:47]
    v_mfma_f32_32x32x16_bf16 v[48:63], v[132:135], v[120:123], v[48:63]
    v_mfma_f32_32x32x16_bf16 v[64:79], v[136:139], v[120:123], v[64:79]
    v_mfma_f32_32x32x16_bf16 v[80:95], v[140:143], v[120:123], v[80:95]
    s_waitcnt vmcnt(0)
    s_barrier
    ds_read_b128 v[96:99], v148 offset:0
    ds_read_b64_tr_b16 v[100:101], v157 offset:0
    ds_read_b64_tr_b16 v[102:103], v157 offset:1280
    ds_read_b64_tr_b16 v[104:105], v158 offset:0
    ds_read_b64_tr_b16 v[106:107], v158 offset:1280
    ds_read_b64_tr_b16 v[108:109], v159 offset:0
    ds_read_b64_tr_b16 v[110:111], v159 offset:1280
    ds_read_b64_tr_b16 v[112:113], v160 offset:0
    ds_read_b64_tr_b16 v[114:115], v160 offset:1280
    ds_read_b64_tr_b16 v[116:117], v161 offset:0
    ds_read_b64_tr_b16 v[118:119], v161 offset:1280
    ds_read_b128 v[120:123], v149 offset:0
    ds_read_b64_tr_b16 v[124:125], v157 offset:5120
    ds_read_b64_tr_b16 v[126:127], v157 offset:6400
    ds_read_b64_tr_b16 v[128:129], v158 offset:5120
    ds_read_b64_tr_b16 v[130:131], v158 offset:6400
    ds_read_b64_tr_b16 v[132:133], v159 offset:5120
    ds_read_b64_tr_b16 v[134:135], v159 offset:6400
    ds_read_b64_tr_b16 v[136:137], v160 offset:5120
    ds_read_b64_tr_b16 v[138:139], v160 offset:6400
    ds_read_b64_tr_b16 v[140:141], v161 offset:5120
    ds_read_b64_tr_b16 v[142:143], v161 offset:6400
    s_waitcnt lgkmcnt(11)
    v_mfma_f32_32x32x16_bf16 v[16:31], v[100:103], v[96:99], v[16:31]
    v_mfma_f32_32x32x16_bf16 v[32:47], v[104:107], v[96:99], v[32:47]
    v_mfma_f32_32x32x16_bf16 v[48:63], v[108:111], v[96:99], v[48:63]
    v_mfma_f32_32x32x16_bf16 v[64:79], v[112:115], v[96:99], v[64:79]
    v_mfma_f32_32x32x16_bf16 v[80:95], v[116:119], v[96:99], v[80:95]
    ds_read_b128 v[96:99], v150 offset:0
    ds_read_b64_tr_b16 v[100:101], v157 offset:10240
    ds_read_b64_tr_b16 v[102:103], v157 offset:11520
    ds_read_b64_tr_b16 v[104:105], v158 offset:10240
    ds_read_b64_tr_b16 v[106:107], v158 offset:11520
    ds_read_b64_tr_b16 v[108:109], v159 offset:10240
    ds_read_b64_tr_b16 v[110:111], v159 offset:11520
    ds_read_b64_tr_b16 v[112:113], v160 offset:10240
    ds_read_b64_tr_b16 v[114:115], v160 offset:11520
    ds_read_b64_tr_b16 v[116:117], v161 offset:10240
    ds_read_b64_tr_b16 v[118:119], v161 offset:11520
    s_waitcnt lgkmcnt(11)
    v_mfma_f32_32x32x16_bf16 v[16:31], v[124:127], v[120:123], v[16:31]
    v_mfma_f32_32x32x16_bf16 v[32:47], v[128:131], v[120:123], v[32:47]
    v_mfma_f32_32x32x16_bf16 v[48:63], v[132:135], v[120:123], v[48:63]
    v_mfma_f32_32x32x16_bf16 v[64:79], v[136:139], v[120:123], v[64:79]
    v_mfma_f32_32x32x16_bf16 v[80:95], v[140:143], v[120:123], v[80:95]
    ds_read_b128 v[120:123], v151 offset:0
    ds_read_b64_tr_b16 v[124:125], v157 offset:15360
    ds_read_b64_tr_b16 v[126:127], v157 offset:16640
    ds_read_b64_tr_b16 v[128:129], v158 offset:15360
    ds_read_b64_tr_b16 v[130:131], v158 offset:16640
    ds_read_b64_tr_b16 v[132:133], v159 offset:15360
    ds_read_b64_tr_b16 v[134:135], v159 offset:16640
    ds_read_b64_tr_b16 v[136:137], v160 offset:15360
    ds_read_b64_tr_b16 v[138:139], v160 offset:16640
    ds_read_b64_tr_b16 v[140:141], v161 offset:15360
    ds_read_b64_tr_b16 v[142:143], v161 offset:16640
    s_waitcnt lgkmcnt(11)
    v_mfma_f32_32x32x16_bf16 v[16:31], v[100:103], v[96:99], v[16:31]
    v_mfma_f32_32x32x16_bf16 v[32:47], v[104:107], v[96:99], v[32:47]
    v_mfma_f32_32x32x16_bf16 v[48:63], v[108:111], v[96:99], v[48:63]
    v_mfma_f32_32x32x16_bf16 v[64:79], v[112:115], v[96:99], v[64:79]
    v_mfma_f32_32x32x16_bf16 v[80:95], v[116:119], v[96:99], v[80:95]
    s_waitcnt lgkmcnt(0)
    v_mfma_f32_32x32x16_bf16 v[16:31], v[124:127], v[120:123], v[16:31]
    v_mfma_f32_32x32x16_bf16 v[32:47], v[128:131], v[120:123], v[32:47]
    v_mfma_f32_32x32x16_bf16 v[48:63], v[132:135], v[120:123], v[48:63]
    v_mfma_f32_32x32x16_bf16 v[64:79], v[136:139], v[120:123], v[64:79]
    v_mfma_f32_32x32x16_bf16 v[80:95], v[140:143], v[120:123], v[80:95]
    v_lshlrev_b32 v170, 4, v1
    s_mul_i32 s27, s24, 81920
    s_add_u32 s28, s27, 0
    s_nop 4
    buffer_store_dwordx4 v[16:19], v170, s[20:23], s28 offen
    s_add_u32 s28, s27, 1024
    buffer_store_dwordx4 v[20:23], v170, s[20:23], s28 offen
    s_add_u32 s28, s27, 2048
    buffer_store_dwordx4 v[24:27], v170, s[20:23], s28 offen
    s_add_u32 s28, s27, 3072
    buffer_store_dwordx4 v[28:31], v170, s[20:23], s28 offen
    s_add_u32 s28, s27, 4096
    buffer_store_dwordx4 v[32:35], v170, s[20:23], s28 offen
    s_add_u32 s28, s27, 5120
    buffer_store_dwordx4 v[36:39], v170, s[20:23], s28 offen
    s_add_u32 s28, s27, 6144
    buffer_store_dwordx4 v[40:43], v170, s[20:23], s28 offen
    s_add_u32 s28, s27, 7168
    buffer_store_dwordx4 v[44:47], v170, s[20:23], s28 offen
    s_add_u32 s28, s27, 8192
    buffer_store_dwordx4 v[48:51], v170, s[20:23], s28 offen
    s_add_u32 s28, s27, 9216
    buffer_store_dwordx4 v[52:55], v170, s[20:23], s28 offen
    s_add_u32 s28, s27, 10240
    buffer_store_dwordx4 v[56:59], v170, s[20:23], s28 offen
    s_add_u32 s28, s27, 11264
    buffer_store_dwordx4 v[60:63], v170, s[20:23], s28 offen
    s_add_u32 s28, s27, 12288
    buffer_store_dwordx4 v[64:67], v170, s[20:23], s28 offen
    s_add_u32 s28, s27, 13312
    buffer_store_dwordx4 v[68:71], v170, s[20:23], s28 offen
    s_add_u32 s28, s27, 14336
    buffer_store_dwordx4 v[72:75], v170, s[20:23], s28 offen
    s_add_u32 s28, s27, 15360
    buffer_store_dwordx4 v[76:79], v170, s[20:23], s28 offen
    s_add_u32 s28, s27, 16384
    buffer_store_dwordx4 v[80:83], v170, s[20:23], s28 offen
    s_add_u32 s28, s27, 17408
    buffer_store_dwordx4 v[84:87], v170, s[20:23], s28 offen
    s_add_u32 s28, s27, 18432
    buffer_store_dwordx4 v[88:91], v170, s[20:23], s28 offen
    s_add_u32 s28, s27, 19456
    buffer_store_dwordx4 v[92:95], v170, s[20:23], s28 offen
    s_waitcnt vmcnt(0)
gemm3_kernel_exit:
    s_endpgm
.globl reduce_kernel
.p2align 8
.type reduce_kernel,@function
reduce_kernel:
    s_cmp_ge_u32 s2, 1280
    s_cbranch_scc1 reduce_kernel_exit
    s_load_dwordx2 s[4:5], s[0:1], 96
    s_load_dwordx2 s[6:7], s[0:1], 80
    s_waitcnt lgkmcnt(0)
    s_add_u32 s8, s4, 67108864
    s_addc_u32 s9, s5, 0
    s_mov_b32 s10, 41943040
    s_mov_b32 s11, 0x00020000
    s_add_u32 s12, s6, 0
    s_addc_u32 s13, s7, 0
    s_mov_b32 s14, 4915200
    s_mov_b32 s15, 0x00020000
    v_and_b32 v1, 63, v0
    v_lshrrev_b32 v2, 6, v0
    s_nop 0
    v_readfirstlane_b32 s16, v2
    s_lshl_b32 s17, s2, 2
    s_add_u32 s17, s17, s16
    v_lshlrev_b32 v2, 4, v1
    s_lshl_b32 s18, s17, 11
    s_add_u32 s19, s18, 0
    buffer_load_dwordx4 v[8:11], v2, s[8:11], s19 offen
    buffer_load_dwordx4 v[12:15], v2, s[8:11], s19 offen offset:1024
    s_add_u32 s19, s18, 10485760
    buffer_load_dwordx4 v[16:19], v2, s[8:11], s19 offen
    buffer_load_dwordx4 v[20:23], v2, s[8:11], s19 offen offset:1024
    s_add_u32 s19, s18, 20971520
    buffer_load_dwordx4 v[24:27], v2, s[8:11], s19 offen
    buffer_load_dwordx4 v[28:31], v2, s[8:11], s19 offen offset:1024
    s_add_u32 s19, s18, 31457280
    buffer_load_dwordx4 v[32:35], v2, s[8:11], s19 offen
    buffer_load_dwordx4 v[36:39], v2, s[8:11], s19 offen offset:1024
    s_and_b32 s20, s17, 1
    s_lshr_b32 s21, s17, 1
    s_mov_b32 s22, 0xcccccccd
    s_mul_hi_u32 s23, s21, s22
    s_lshr_b32 s23, s23, 4
    s_mul_i32 s24, s23, 20
    s_sub_u32 s24, s21, s24
    s_and_b32 s25, s23, 7
    s_lshr_b32 s26, s23, 3
    s_and_b32 s27, s26, 7
    s_lshr_b32 s26, s26, 3
    s_lshl_b32 s25, s25, 5
    v_and_b32 v3, 31, v1
    v_add_u32 v3, s25, v3
    v_cmp_gt_u32 vcc, 240, v3
    s_mul_i32 s27, s27, 240
    v_add_u32 v3, s27, v3
    v_mul_u32_u24 v3, 2560, v3
    s_mul_i32 s26, s26, 1280
    s_lshl_b32 s24, s24, 6
    s_add_u32 s26, s26, s24
    s_lshl_b32 s20, s20, 5
    s_add_u32 s26, s26, s20
    v_lshrrev_b32 v4, 5, v1
    v_lshlrev_b32 v4, 4, v4
    v_add_u32 v3, v3, v4
    v_add_u32 v3, s26, v3
    v_mov_b32 v4, 0x80000000
    v_cndmask_b32 v5, v4, v3, vcc
    s_waitcnt vmcnt(0)
    v_add_f32 v8, v8, v16
    v_add_f32 v24, v24, v32
    v_add_f32 v8, v8, v24
    v_add_f32 v9, v9, v17
    v_add_f32 v25, v25, v33
    v_add_f32 v9, v9, v25
    v_add_f32 v10, v10, v18
    v_add_f32 v26, v26, v34
    v_add_f32 v10, v10, v26
    v_add_f32 v11, v11, v19
    v_add_f32 v27, v27, v35
    v_add_f32 v11, v11, v27
    v_add_f32 v12, v12, v20
    v_add_f32 v28, v28, v36
    v_add_f32 v12, v12, v28
    v_add_f32 v13, v13, v21
    v_add_f32 v29, v29, v37
    v_add_f32 v13, v13, v29
    v_add_f32 v14, v14, v22
    v_add_f32 v30, v30, v38
    v_add_f32 v14, v14, v30
    v_add_f32 v15, v15, v23
    v_add_f32 v31, v31, v39
    v_add_f32 v15, v15, v31
    v_cvt_pk_bf16_f32 v40, v8, v9
    v_cvt_pk_bf16_f32 v41, v10, v11
    v_cvt_pk_bf16_f32 v42, v12, v13
    v_cvt_pk_bf16_f32 v43, v14, v15
    s_nop 0
    v_permlane32_swap_b32 v40, v42
    v_permlane32_swap_b32 v41, v43
    buffer_store_dwordx4 v[40:43], v5, s[12:15], 0 offen
    s_waitcnt vmcnt(0)
reduce_kernel_exit:
    s_endpgm
.section .rodata,"a"
.p2align 6
.amdhsa_kernel gemm1_kernel
  .amdhsa_next_free_vgpr 228
  .amdhsa_next_free_sgpr 102
  .amdhsa_accum_offset 228
  .amdhsa_group_segment_fixed_size 0
  .amdhsa_kernarg_size 104
  .amdhsa_user_sgpr_count 2
  .amdhsa_user_sgpr_kernarg_segment_ptr 1
  .amdhsa_system_sgpr_workgroup_id_x 1
.end_amdhsa_kernel
.p2align 6
.amdhsa_kernel attn_kernel
  .amdhsa_next_free_vgpr 228
  .amdhsa_next_free_sgpr 102
  .amdhsa_accum_offset 228
  .amdhsa_group_segment_fixed_size 0
  .amdhsa_kernarg_size 104
  .amdhsa_user_sgpr_count 2
  .amdhsa_user_sgpr_kernarg_segment_ptr 1
  .amdhsa_system_sgpr_workgroup_id_x 1
.end_amdhsa_kernel
.p2align 6
.amdhsa_kernel gemm3_kernel
  .amdhsa_next_free_vgpr 182
  .amdhsa_next_free_sgpr 102
  .amdhsa_accum_offset 184
  .amdhsa_group_segment_fixed_size 0
  .amdhsa_kernarg_size 104
  .amdhsa_user_sgpr_count 2
  .amdhsa_user_sgpr_kernarg_segment_ptr 1
  .amdhsa_system_sgpr_workgroup_id_x 1
.end_amdhsa_kernel
.p2align 6
.amdhsa_kernel reduce_kernel
  .amdhsa_next_free_vgpr 48
  .amdhsa_next_free_sgpr 102
  .amdhsa_accum_offset 48
  .amdhsa_group_segment_fixed_size 0
  .amdhsa_kernarg_size 104
  .amdhsa_user_sgpr_count 2
  .amdhsa_user_sgpr_kernarg_segment_ptr 1
  .amdhsa_system_sgpr_workgroup_id_x 1
.end_amdhsa_kernel
```
